```python
import torch

def _softmax(x, axis=-1):
    return torch.softmax(x, dim=axis)
def _gelu(x):
    return torch.nn.functional.gelu(x, approximate="tanh")
def _silu(x):
    return torch.nn.functional.silu(x)
def _sigmoid(x):
    return torch.sigmoid(x)
def _layernorm(x, axis=-1, eps=1e-5):
    m = x.mean(dim=axis, keepdim=True)
    v = x.var(dim=axis, keepdim=True, unbiased=False)
    return (x - m) / torch.sqrt(v + eps)
def _scatter_add(tgt, idx, src, axis=0):
    return tgt.clone().index_add_(axis, idx, src)
def _segment_sum(src, seg, n):
    out = torch.zeros((n,) + src.shape[1:], dtype=src.dtype)
    return out.index_add_(0, seg, src)
def _pad(x, pw):
    flat = tuple(v for pair in reversed(pw) for v in pair)
    return torch.nn.functional.pad(x, flat)

kernel_name = 'gated_mix__ssm_conv_s4d__swiglu_ffn__prompt'

def setup_inputs():

    _w = (lambda a: (lambda t: t.to(torch.bfloat16) if t.is_floating_point() else t)(torch.as_tensor(a)))
    def _A_setup():
        Bsz, L, D, N = 1, 2048, 640, 192
        return {
            "u": _w((lambda *s: torch.randn(*s, dtype=torch.bfloat16) * 0.05)(Bsz, L, D)),
            "log_A_real": _w((lambda *s: torch.randn(*s, dtype=torch.bfloat16) * 6.4)(D, N) * 0.5),
            "A_imag": _w((lambda *s: torch.randn(*s, dtype=torch.bfloat16) * 0.05)(D, N) * 3.14),
            "C_real": _w((lambda *s: torch.randn(*s, dtype=torch.bfloat16) * 0.05)(D, N) / N ** 0.5),
            "C_imag": _w((lambda *s: torch.randn(*s, dtype=torch.bfloat16) * 0.05)(D, N) / N ** 0.5),
            "log_dt": _w((lambda *s: torch.randn(*s, dtype=torch.bfloat16) * 0.05)(D) * 0.5 - 4.0),
            "D_skip": _w((lambda *s: torch.randn(*s, dtype=torch.bfloat16) * 0.05)(D)),
        }
    _A_in = _A_setup()

    def _B_setup():
        B, S, D, F = 1, 2048, 640, 1536
        return {
            "x": _w((lambda *s: torch.randn(*s, dtype=torch.bfloat16) * 0.05)(B, S, D)),
            "w_gate": _w((lambda *s: torch.randn(*s, dtype=torch.bfloat16) * 0.05)(D, F)),
            "w_up": _w((lambda *s: torch.randn(*s, dtype=torch.bfloat16) * 0.05)(D, F)),
            "w_down": _w((lambda *s: torch.randn(*s, dtype=torch.bfloat16) * 0.05)(F, D)),
        }
    _B_in = _B_setup()

    return {
        "A_u": _A_in["u"],
        "A_log_A_real": _A_in["log_A_real"],
        "A_A_imag": _A_in["A_imag"],
        "A_C_real": _A_in["C_real"],
        "A_C_imag": _A_in["C_imag"],
        "A_log_dt": _A_in["log_dt"],
        "A_D_skip": _A_in["D_skip"],
        "B_x": _B_in["x"],
        "B_w_gate": _B_in["w_gate"],
        "B_w_up": _B_in["w_up"],
        "B_w_down": _B_in["w_down"],
        "gate_w": _w((lambda *s: torch.randn(*s, dtype=torch.bfloat16) * 0.05)(640) * 16.0),
    }

def reference(A_u, A_log_A_real, A_A_imag, A_C_real, A_C_imag, A_log_dt, A_D_skip, B_x, B_w_gate, B_w_up, B_w_down, gate_w):
    def _A_ref(u, log_A_real, A_imag, C_real, C_imag, log_dt, D_skip):
        L = u.shape[1]
        dt = torch.exp(log_dt)
        A = -torch.exp(log_A_real) + 1j * A_imag
        C = (C_real + 1j * C_imag) * dt[:, None]
        pos = (lambda x, dt: x.to(dt))(torch.arange(L), log_dt.dtype)
        P = torch.exp((A * dt[:, None])[:, :, None] * pos[None, None, :])
        K = 2.0 * torch.einsum("dn,dnl->dl", C, P).real
        L2 = 2 * L
        u_t = (lambda x, *d: x.permute(*d))(u, 0, 2, 1)
        Kf = (lambda x, *a, **k: torch.fft.rfft(x.float(), *a, **k))(K, L2)
        Uf = (lambda x, *a, **k: torch.fft.rfft(x.float(), *a, **k))(u_t, L2)
        y = (lambda x, *a, **k: torch.fft.irfft(x, *a, **k).to(torch.bfloat16))(Uf * Kf[None, :, :], L2)[:, :, :L]
        y = (lambda x, *d: x.permute(*d))(y, 0, 2, 1)
        return y + u * D_skip[None, None, :]

    def _B_ref(x, w_gate, w_up, w_down):
        g = _silu(x @ w_gate)
        u = x @ w_up
        return (g * u) @ w_down

    x = A_u
    g = _sigmoid((x * gate_w).sum(-1, keepdims=True))
    a = _A_ref(x, A_log_A_real, A_A_imag, A_C_real, A_C_imag, A_log_dt, A_D_skip)
    b = _B_ref(x, B_w_gate, B_w_up, B_w_down)
    return g * a + (1 - g) * b
```

```asm
; @launch grid=(256,1,1) block=(512,1,1) lds=163256
.amdgcn_target "amdgcn-amd-amdhsa--gfx950"
.text
.globl gated_mix__ssm_conv_s4d__swiglu_ffn__prompt_kernel
.p2align 8
.type gated_mix__ssm_conv_s4d__swiglu_ffn__prompt_kernel,@function
gated_mix__ssm_conv_s4d__swiglu_ffn__prompt_kernel:
    s_cmp_ge_u32 s2, 256
    s_cbranch_scc1 k_end
    s_getpc_b64 s[24:25]
k_pc:
    s_load_dwordx16 s[32:47], s[0:1], 0
    s_lshr_b32 s97, s2, 3
    v_lshrrev_b32 v1, 6, v0
    v_lshl_add_u32 v2, v1, 5, s97
    v_lshlrev_b32_e64 v2, 7, v2
    v_min_u32 v2, k_last - k_pc, v2
    v_mov_b32 v5, s25
    v_add_co_u32 v4, vcc, s24, v2
    v_addc_co_u32 v5, vcc, 0, v5, vcc
    global_load_dword v15, v[4:5], off
    v_readfirstlane_b32 s3, v1
    s_load_dwordx8 s[48:55], s[0:1], 64
    s_load_dwordx4 s[56:59], s[0:1], 96
    s_load_dwordx2 s[20:21], s[0:1], 112
    v_and_b32 v0, 63, v0
    s_and_b32 s96, s2, 7
    s_cmp_lg_u32 s3, 4
    s_cbranch_scc1 k_k
    v_lshlrev_b32_e64 v8, 2, v0
    v_add_u32 v8, 162624, v8
    v_mov_b32_e64 v9, 1
    ds_write_b32 v8, v9
    s_branch k_l
k_k:
    s_mov_b32 s10, 0x56695594
    s_mov_b32 s11, 0x42814000
    s_lshr_b32 s18, s97, 1
    s_lshl_b32 s18, s18, 3
    s_add_u32 s18, s18, s96
    s_and_b32 s8, s97, 1
    s_cselect_b32 s10, 0x69556854, s10
    s_cselect_b32 s11, 0x22818000, s11
    s_lshl_b32 s9, s3, 3
    s_lshr_b64 s[10:11], s[10:11], s9
    s_and_b32 s100, s10, 3
    s_bfe_u32 s17, s10, 0x20004
    s_bfe_u32 s16, s10, 0x20006
    s_cmp_lt_u32 s3, 4
    s_cselect_b32 s14, s16, 1
    s_mul_i32 s9, s8, 3
    s_add_u32 s9, s9, s100
    s_cmp_eq_u32 s100, 2
    s_cselect_b32 s9, 2, s9
    s_cselect_b32 s13, s16, 0
    s_mul_i32 s60, s18, 5
    s_add_u32 s60, s60, s9
    s_mul_i32 s28, s60, 384
    s_lshl_b32 s29, s17, 7
    s_add_u32 s28, s28, s29
    v_lshl_add_u32 v1, v0, 1, s28
    s_lshl_b32 s28, s60, 1
    s_and_b32 s28, s28, -4
    s_cmp_lt_u32 s14, 2
    s_waitcnt lgkmcnt(0)
    global_load_ushort v246, v1, s[34:35]
    global_load_ushort v247, v1, s[36:37]
    global_load_ushort v248, v1, s[38:39]
    global_load_ushort v249, v1, s[40:41]
    s_cbranch_scc1 k_one
    global_load_ushort v250, v1, s[34:35] offset:128
    global_load_ushort v251, v1, s[36:37] offset:128
    global_load_ushort v252, v1, s[38:39] offset:128
    global_load_ushort v253, v1, s[40:41] offset:128
k_one:
    s_load_dword s30, s[42:43], s28
    s_load_dword s31, s[44:45], s28
    s_barrier
    s_lshl_b32 s24, s2, 3
    s_add_u32 s24, s24, s3
    s_cmp_lg_u32 s24, 71
    s_cbranch_scc1 mk_1
    s_add_u32 s24, s20, 12165120
    s_addc_u32 s25, s21, 0
    s_load_dword s28, s[24:25], 0
    v_mov_b32 v16, 0
    s_waitcnt lgkmcnt(0)
    s_add_u32 s28, s28, 1
    s_max_u32 s28, s28, 1
    v_mov_b32 v17, s28
    s_mov_b64 exec, 1
    global_store_dword v16, v17, s[58:59] sc1
    global_store_dword v16, v17, s[24:25] sc1
    s_mov_b64 exec, -1
mk_1:
    s_mul_i32 s98, s97, 52
    s_lshr_b32 s98, s98, 8
    s_and_b32 s99, s96, 3
    s_lshr_b32 s6, s96, 2
    s_sub_u32 s4, s6, s98
    s_mul_i32 s4, s4, 5
    s_add_u32 s4, s4, s97
    s_mul_i32 s5, s99, 6
    s_add_u32 s5, s5, s98
    s_lshl_b32 s7, s99, 1
    s_add_u32 s7, s7, s6
    s_lshl_b32 s7, s7, 1
    s_add_u32 s7, s7, s97
    s_sub_u32 s7, s7, 30
    s_cmp_ge_u32 s2, 240
    s_cselect_b32 s4, 15, s4
    s_cselect_b32 s5, s7, s5
    s_lshr_b32 s6, s96, 1
    s_lshl_b32 s6, s6, 3
    s_and_b32 s7, s97, 7
    s_add_u32 s6, s6, s7
    s_and_b32 s7, s96, 1
    s_lshl_b32 s7, s7, 2
    s_lshr_b32 s22, s97, 3
    s_add_u32 s7, s7, s22
    s_mov_b32 s22, 0x2000000
    s_mov_b32 s23, 0x20000
    s_bfe_u32 s9, s10, 0x20002
    s_mul_i32 s101, s100, 13184
    s_add_u32 s101, s101, 123072
    s_mul_i32 s19, s9, 4352
    s_add_u32 s19, s19, s101
    s_mov_b32 m0, s19
    v_and_b32 v17, 15, v0
    v_lshrrev_b32 v18, 4, v0
    v_mov_b32 v10, 0
    v_mov_b32 v9, 0
    v_mov_b32 v7, 0
    v_mov_b32 v170, 0
    s_mov_b32 s24, 0x3fb8aa3b
    s_mov_b32 s25, 0x32a57060
    s_mov_b32 s26, 0x3f317218
    s_mov_b32 s27, 0x41000000
    s_mov_b32 s28, 0x43000000
    v_add_u32 v37, 4, v17
    v_and_b32 v16, 7, v37
    v_mul_u32_u24 v16, 544, v16
    v_and_b32_e64 v37, 8, v37
    v_lshl_add_u32 v16, v37, 5, v16
    v_lshl_add_u32 v16, v18, 4, v16
    v_add_u32_e64 v16, s19, v16
    v_pk_mov_b32 v[20:21], 0, 0
    v_pk_mov_b32 v[22:23], 0, 0
    v_pk_mov_b32 v[24:25], 0, 0
    v_pk_mov_b32 v[26:27], 0, 0
    v_pk_mov_b32 v[28:29], 0, 0
    v_pk_mov_b32 v[30:31], 0, 0
    v_mov_b32 v36, 0x3f80
    v_lshlrev_b32 v1, 4, v0
    s_cmp_ge_u32 s3, 4
    s_cbranch_scc1 k_nosetup
    s_lshr_b32 s8, s3, 1
    s_and_b32 s9, s3, 1
    v_mov_b32 v7, 162680
    s_mov_b32 s54, 0xbfb8aa3b
    s_mov_b32 s55, 0xbfb8aa3b
    s_lshl_b32 s52, s6, 2
    s_add_u32 s52, s52, s3
    s_lshl_b32 s52, s52, 8
    s_add_u32 s52, s52, 11550720
    s_mul_i32 s53, s6, 196608
    s_mul_i32 s10, s3, 49152
    s_add_u32 s53, s53, s10
    s_mul_i32 s10, s3, 10240
    v_add_u32 v11, s10, v1
    s_cmp_ge_u32 s2, 240
    s_cbranch_scc1 k_ss
    v_bfe_u32 v12, v0, 1, 3
    v_xor_b32 v12, v12, v18
    v_lshlrev_b32_e64 v2, 7, v17
    v_lshl_add_u32 v2, v12, 4, v2
    s_mul_i32 s10, s8, 0x3000
    v_add_u32 v2, s10, v2
    v_xor_b32 v3, 64, v2
    v_bfe_u32 v12, v0, 2, 2
    v_lshl_add_u32 v12, v18, 3, v12
    v_lshlrev_b32_e64 v6, 7, v12
    v_bfe_u32 v12, v0, 4, 1
    v_xor_b32_e64 v12, s9, v12
    v_lshl_add_u32 v6, v12, 6, v6
    v_bfe_u32 v12, v0, 1, 1
    v_lshl_add_u32 v6, v12, 5, v6
    v_bfe_u32 v12, v0, 3, 1
    v_lshl_add_u32 v6, v12, 4, v6
    v_and_b32_e64 v12, 1, v0
    v_lshl_add_u32 v6, v12, 3, v6
    v_add_u32 v6, 24576, v6
    v_xor_b32 v8, 16, v6
    v_mov_b32 v10, v1
    v_add_u32 v9, 1024, v1
    s_lshl_b32 s11, s4, 1
    s_add_u32 s11, s11, s8
    s_mul_i32 s11, s11, 3
    s_lshl_b32 s12, s5, 1
    s_add_u32 s12, s12, s9
    s_lshl_b32 s12, s12, 12
    s_add_u32 s13, s11, 0
    s_lshr_b32 s10, s13, 1
    s_mul_i32 s10, s10, 196608
    s_and_b32 s13, s13, 1
    s_lshl_b32 s13, s13, 11
    s_add_u32 s10, s10, s13
    s_add_u32 s48, s10, s12
    s_add_u32 s13, s11, 1
    s_lshr_b32 s10, s13, 1
    s_mul_i32 s10, s10, 196608
    s_and_b32 s13, s13, 1
    s_lshl_b32 s13, s13, 11
    s_add_u32 s10, s10, s13
    s_add_u32 s49, s10, s12
    s_add_u32 s13, s11, 2
    s_lshr_b32 s10, s13, 1
    s_mul_i32 s10, s10, 196608
    s_and_b32 s13, s13, 1
    s_lshl_b32 s13, s13, 11
    s_add_u32 s10, s10, s13
    s_add_u32 s50, s10, s12
    s_mul_i32 s51, s4, 12
    s_add_u32 s51, s51, s99
    s_lshl_b32 s51, s51, 8
    s_lshl_b32 s10, s98, 1
    s_add_u32 s10, s10, s9
    s_lshl_b32 s10, s10, 3
    s_add_u32 s51, s51, s10
    s_add_u32 s51, s51, 11550720
    s_lshl_b32 s46, s8, 11
    s_lshl_b32 s47, s8, 2
    s_add_u32 s47, s47, 0x400
k_nosetup:
    s_waitcnt lgkmcnt(0)
    s_bitcmp1_b32 s60, 0
    s_cselect_b32 s29, 0, 16
    s_lshl_b32 s30, s30, s29
    s_and_b32 s30, s30, 0xffff0000
    s_lshl_b32 s31, s31, s29
    s_and_b32 s31, s31, 0xffff0000
    s_cmp_eq_u32 s17, 0
    s_cselect_b32 s31, s31, 0
    v_mov_b32_e64 v37, s30
    v_writelane_b32 v20, s31, 0
    v_mul_f32_e64 v38, s24, v37
    v_fma_f32 v39, v37, s24, -v38
    v_fmac_f32 v39, s25, v37
    v_exp_f32 v38, v38
    v_mul_f32 v39, s26, v39
    v_fmac_f32 v38, v38, v39
    v_cvt_pk_bf16_f32 v38, v38, v38
    v_lshlrev_b32 v32, 16, v38
    v_add_f32 v34, v32, v32
    v_sub_f32 v33, 0, v32
    s_waitcnt vmcnt(0)
k_loop:
    v_lshlrev_b32 v240, 16, v246
    v_mul_f32 v240, s24, v240
    v_lshlrev_b32 v39, 16, v247
    v_exp_f32 v240, v240
    v_lshlrev_b32 v48, 16, v248
    v_lshlrev_b32 v49, 16, v249
    v_cvt_pk_bf16_f32 v240, v240, v240
    v_mul_f32 v39, v39, v32
    v_lshlrev_b32 v240, 16, v240
    v_mul_f32 v39, 0.15915494, v39
    v_mul_f32 v38, v240, v33
    v_pk_mul_f32 v[48:49], v[48:49], v[34:35] op_sel_hi:[1,0]
    v_mul_f32_e64 v38, s24, v38
    v_pk_mov_b32 v[246:247], v[250:251], v[250:251] op_sel:[0,1]
    v_pk_mov_b32 v[248:249], v[252:253], v[252:253] op_sel:[0,1]
    v_mul_f32 v240, s27, v38
    v_mul_f32 v241, s27, v39
    v_exp_f32 v240, v240
    v_fract_f32 v241, v241
    v_cos_f32 v42, v241
    v_sin_f32 v43, v241
    s_nop 0
    v_pk_mul_f32 v[42:43], v[42:43], v[240:241] op_sel_hi:[1,0] neg_hi:[1,0]
    v_exp_f32 v240, v38
    v_fract_f32 v241, v39
    v_cos_f32 v40, v241
    v_sin_f32 v41, v241
    s_nop 0
    v_pk_mul_f32 v[40:41], v[40:41], v[240:241] op_sel_hi:[1,0]
    v_mul_f32 v240, s28, v38
    v_mul_f32 v241, s28, v39
    v_exp_f32 v240, v240
    v_fract_f32 v241, v241
    v_cos_f32 v44, v241
    v_sin_f32 v45, v241
    s_nop 0
    s_nop 0
    v_pk_mul_f32 v[44:45], v[44:45], v[240:241] op_sel_hi:[1,0]
    v_pk_mul_f32 v[242:243], v[42:43], v[42:43] op_sel:[0,0] op_sel_hi:[1,0]
    v_pk_fma_f32 v[242:243], v[42:43], v[42:43], v[242:243] op_sel:[1,1,0] op_sel_hi:[0,1,1] neg_lo:[0,1,0]
    v_cvt_pk_bf16_f32 v64, v42, v43
    v_pk_mul_f32 v[50:51], v[48:49], v[40:41] op_sel:[0,0] op_sel_hi:[1,0]
    v_pk_fma_f32 v[50:51], v[48:49], v[40:41], v[50:51] op_sel:[1,1,0] op_sel_hi:[0,1,1] neg_lo:[0,1,0]
    v_pk_mul_f32 v[244:245], v[242:243], v[42:43] op_sel:[0,0] op_sel_hi:[1,0]
    v_pk_fma_f32 v[244:245], v[242:243], v[42:43], v[244:245] op_sel:[1,1,0] op_sel_hi:[0,1,1] neg_lo:[0,1,0]
    v_cvt_pk_bf16_f32 v65, v242, v243
    v_pk_mul_f32 v[52:53], v[50:51], v[40:41] op_sel:[0,0] op_sel_hi:[1,0]
    v_pk_fma_f32 v[52:53], v[50:51], v[40:41], v[52:53] op_sel:[1,1,0] op_sel_hi:[0,1,1] neg_lo:[0,1,0]
    v_pk_mul_f32 v[242:243], v[244:245], v[42:43] op_sel:[0,0] op_sel_hi:[1,0]
    v_pk_fma_f32 v[242:243], v[244:245], v[42:43], v[242:243] op_sel:[1,1,0] op_sel_hi:[0,1,1] neg_lo:[0,1,0]
    v_cvt_pk_bf16_f32 v66, v244, v245
    v_pk_mul_f32 v[54:55], v[52:53], v[40:41] op_sel:[0,0] op_sel_hi:[1,0]
    v_pk_fma_f32 v[54:55], v[52:53], v[40:41], v[54:55] op_sel:[1,1,0] op_sel_hi:[0,1,1] neg_lo:[0,1,0]
    v_pk_mul_f32 v[244:245], v[242:243], v[42:43] op_sel:[0,0] op_sel_hi:[1,0]
    v_pk_fma_f32 v[244:245], v[242:243], v[42:43], v[244:245] op_sel:[1,1,0] op_sel_hi:[0,1,1] neg_lo:[0,1,0]
    v_cvt_pk_bf16_f32 v67, v242, v243
    v_pk_mul_f32 v[56:57], v[54:55], v[40:41] op_sel:[0,0] op_sel_hi:[1,0]
    v_pk_fma_f32 v[56:57], v[54:55], v[40:41], v[56:57] op_sel:[1,1,0] op_sel_hi:[0,1,1] neg_lo:[0,1,0]
    v_pk_mul_f32 v[242:243], v[244:245], v[42:43] op_sel:[0,0] op_sel_hi:[1,0]
    v_pk_fma_f32 v[242:243], v[244:245], v[42:43], v[242:243] op_sel:[1,1,0] op_sel_hi:[0,1,1] neg_lo:[0,1,0]
    v_cvt_pk_bf16_f32 v68, v244, v245
    v_pk_mul_f32 v[58:59], v[56:57], v[40:41] op_sel:[0,0] op_sel_hi:[1,0]
    v_pk_fma_f32 v[58:59], v[56:57], v[40:41], v[58:59] op_sel:[1,1,0] op_sel_hi:[0,1,1] neg_lo:[0,1,0]
    v_pk_mul_f32 v[244:245], v[242:243], v[42:43] op_sel:[0,0] op_sel_hi:[1,0]
    v_pk_fma_f32 v[244:245], v[242:243], v[42:43], v[244:245] op_sel:[1,1,0] op_sel_hi:[0,1,1] neg_lo:[0,1,0]
    v_cvt_pk_bf16_f32 v69, v242, v243
    v_pk_mul_f32 v[60:61], v[58:59], v[40:41] op_sel:[0,0] op_sel_hi:[1,0]
    v_pk_fma_f32 v[60:61], v[58:59], v[40:41], v[60:61] op_sel:[1,1,0] op_sel_hi:[0,1,1] neg_lo:[0,1,0]
    v_pk_mul_f32 v[242:243], v[244:245], v[42:43] op_sel:[0,0] op_sel_hi:[1,0]
    v_pk_fma_f32 v[242:243], v[244:245], v[42:43], v[242:243] op_sel:[1,1,0] op_sel_hi:[0,1,1] neg_lo:[0,1,0]
    v_cvt_pk_bf16_f32 v70, v244, v245
    v_pk_mul_f32 v[62:63], v[60:61], v[40:41] op_sel:[0,0] op_sel_hi:[1,0]
    v_pk_fma_f32 v[62:63], v[60:61], v[40:41], v[62:63] op_sel:[1,1,0] op_sel_hi:[0,1,1] neg_lo:[0,1,0]
    v_pk_mul_f32 v[244:245], v[242:243], v[42:43] op_sel:[0,0] op_sel_hi:[1,0]
    v_pk_fma_f32 v[244:245], v[242:243], v[42:43], v[244:245] op_sel:[1,1,0] op_sel_hi:[0,1,1] neg_lo:[0,1,0]
    v_cvt_pk_bf16_f32 v71, v242, v243
    v_pk_mul_f32 v[242:243], v[244:245], v[42:43] op_sel:[0,0] op_sel_hi:[1,0]
    v_pk_fma_f32 v[242:243], v[244:245], v[42:43], v[242:243] op_sel:[1,1,0] op_sel_hi:[0,1,1] neg_lo:[0,1,0]
    v_cvt_pk_bf16_f32 v72, v244, v245
    v_pk_mul_f32 v[244:245], v[242:243], v[42:43] op_sel:[0,0] op_sel_hi:[1,0]
    v_pk_fma_f32 v[244:245], v[242:243], v[42:43], v[244:245] op_sel:[1,1,0] op_sel_hi:[0,1,1] neg_lo:[0,1,0]
    v_cvt_pk_bf16_f32 v73, v242, v243
    v_pk_mul_f32 v[242:243], v[244:245], v[42:43] op_sel:[0,0] op_sel_hi:[1,0]
    v_pk_fma_f32 v[242:243], v[244:245], v[42:43], v[242:243] op_sel:[1,1,0] op_sel_hi:[0,1,1] neg_lo:[0,1,0]
    v_cvt_pk_bf16_f32 v74, v244, v245
    v_pk_mul_f32 v[244:245], v[242:243], v[42:43] op_sel:[0,0] op_sel_hi:[1,0]
    v_pk_fma_f32 v[244:245], v[242:243], v[42:43], v[244:245] op_sel:[1,1,0] op_sel_hi:[0,1,1] neg_lo:[0,1,0]
    v_cvt_pk_bf16_f32 v75, v242, v243
    v_pk_mul_f32 v[242:243], v[244:245], v[42:43] op_sel:[0,0] op_sel_hi:[1,0]
    v_pk_fma_f32 v[242:243], v[244:245], v[42:43], v[242:243] op_sel:[1,1,0] op_sel_hi:[0,1,1] neg_lo:[0,1,0]
    v_cvt_pk_bf16_f32 v76, v244, v245
    v_pk_mul_f32 v[244:245], v[242:243], v[42:43] op_sel:[0,0] op_sel_hi:[1,0]
    v_pk_fma_f32 v[244:245], v[242:243], v[42:43], v[244:245] op_sel:[1,1,0] op_sel_hi:[0,1,1] neg_lo:[0,1,0]
    v_cvt_pk_bf16_f32 v77, v242, v243
    v_cvt_pk_bf16_f32 v78, v244, v245
    v_cvt_pk_bf16_f32 v79, v48, v49
    v_cvt_pk_bf16_f32 v80, v50, v51
    v_pk_mul_f32 v[240:241], v[50:51], v[44:45] op_sel:[0,0] op_sel_hi:[1,0]
    v_pk_fma_f32 v[240:241], v[50:51], v[44:45], v[240:241] op_sel:[1,1,0] op_sel_hi:[0,1,1] neg_lo:[0,1,0]
    v_pk_mul_f32 v[50:51], v[48:49], v[44:45] op_sel:[0,0] op_sel_hi:[1,0]
    v_pk_fma_f32 v[50:51], v[48:49], v[44:45], v[50:51] op_sel:[1,1,0] op_sel_hi:[0,1,1] neg_lo:[0,1,0]
    v_cvt_pk_bf16_f32 v81, v240, v241
    v_cvt_pk_bf16_f32 v82, v50, v51
    v_cvt_pk_bf16_f32 v83, v52, v53
    v_cvt_pk_bf16_f32 v84, v54, v55
    v_pk_mul_f32 v[240:241], v[54:55], v[44:45] op_sel:[0,0] op_sel_hi:[1,0]
    v_pk_fma_f32 v[240:241], v[54:55], v[44:45], v[240:241] op_sel:[1,1,0] op_sel_hi:[0,1,1] neg_lo:[0,1,0]
    v_pk_mul_f32 v[54:55], v[52:53], v[44:45] op_sel:[0,0] op_sel_hi:[1,0]
    v_pk_fma_f32 v[54:55], v[52:53], v[44:45], v[54:55] op_sel:[1,1,0] op_sel_hi:[0,1,1] neg_lo:[0,1,0]
    v_cvt_pk_bf16_f32 v85, v240, v241
    v_cvt_pk_bf16_f32 v86, v54, v55
    v_cvt_pk_bf16_f32 v87, v56, v57
    v_cvt_pk_bf16_f32 v88, v58, v59
    v_pk_mul_f32 v[240:241], v[58:59], v[44:45] op_sel:[0,0] op_sel_hi:[1,0]
    v_pk_fma_f32 v[240:241], v[58:59], v[44:45], v[240:241] op_sel:[1,1,0] op_sel_hi:[0,1,1] neg_lo:[0,1,0]
    v_pk_mul_f32 v[58:59], v[56:57], v[44:45] op_sel:[0,0] op_sel_hi:[1,0]
    v_pk_fma_f32 v[58:59], v[56:57], v[44:45], v[58:59] op_sel:[1,1,0] op_sel_hi:[0,1,1] neg_lo:[0,1,0]
    v_cvt_pk_bf16_f32 v89, v240, v241
    v_cvt_pk_bf16_f32 v90, v58, v59
    v_cvt_pk_bf16_f32 v91, v60, v61
    v_cvt_pk_bf16_f32 v92, v62, v63
    v_pk_mul_f32 v[240:241], v[62:63], v[44:45] op_sel:[0,0] op_sel_hi:[1,0]
    v_pk_fma_f32 v[240:241], v[62:63], v[44:45], v[240:241] op_sel:[1,1,0] op_sel_hi:[0,1,1] neg_lo:[0,1,0]
    v_pk_mul_f32 v[62:63], v[60:61], v[44:45] op_sel:[0,0] op_sel_hi:[1,0]
    v_pk_fma_f32 v[62:63], v[60:61], v[44:45], v[62:63] op_sel:[1,1,0] op_sel_hi:[0,1,1] neg_lo:[0,1,0]
    v_cvt_pk_bf16_f32 v93, v240, v241
    v_cvt_pk_bf16_f32 v94, v62, v63
    v_pk_mul_f32 v[48:49], v[50:51], v[44:45] op_sel:[0,0] op_sel_hi:[1,0]
    v_pk_fma_f32 v[48:49], v[50:51], v[44:45], v[48:49] op_sel:[1,1,0] op_sel_hi:[0,1,1] neg_lo:[0,1,0]
    v_pk_mul_f32 v[52:53], v[54:55], v[44:45] op_sel:[0,0] op_sel_hi:[1,0]
    v_pk_fma_f32 v[52:53], v[54:55], v[44:45], v[52:53] op_sel:[1,1,0] op_sel_hi:[0,1,1] neg_lo:[0,1,0]
    v_pk_mul_f32 v[56:57], v[58:59], v[44:45] op_sel:[0,0] op_sel_hi:[1,0]
    v_pk_fma_f32 v[56:57], v[58:59], v[44:45], v[56:57] op_sel:[1,1,0] op_sel_hi:[0,1,1] neg_lo:[0,1,0]
    v_pk_mul_f32 v[60:61], v[62:63], v[44:45] op_sel:[0,0] op_sel_hi:[1,0]
    v_pk_fma_f32 v[60:61], v[62:63], v[44:45], v[60:61] op_sel:[1,1,0] op_sel_hi:[0,1,1] neg_lo:[0,1,0]
    v_cvt_pk_bf16_f32 v95, v48, v49
    v_cvt_pk_bf16_f32 v96, v52, v53
    v_cvt_pk_bf16_f32 v97, v56, v57
    v_cvt_pk_bf16_f32 v98, v60, v61
    v_pk_mul_f32 v[50:51], v[48:49], v[44:45] op_sel:[0,0] op_sel_hi:[1,0]
    v_pk_fma_f32 v[50:51], v[48:49], v[44:45], v[50:51] op_sel:[1,1,0] op_sel_hi:[0,1,1] neg_lo:[0,1,0]
    v_pk_mul_f32 v[54:55], v[52:53], v[44:45] op_sel:[0,0] op_sel_hi:[1,0]
    v_pk_fma_f32 v[54:55], v[52:53], v[44:45], v[54:55] op_sel:[1,1,0] op_sel_hi:[0,1,1] neg_lo:[0,1,0]
    v_pk_mul_f32 v[58:59], v[56:57], v[44:45] op_sel:[0,0] op_sel_hi:[1,0]
    v_pk_fma_f32 v[58:59], v[56:57], v[44:45], v[58:59] op_sel:[1,1,0] op_sel_hi:[0,1,1] neg_lo:[0,1,0]
    v_pk_mul_f32 v[62:63], v[60:61], v[44:45] op_sel:[0,0] op_sel_hi:[1,0]
    v_pk_fma_f32 v[62:63], v[60:61], v[44:45], v[62:63] op_sel:[1,1,0] op_sel_hi:[0,1,1] neg_lo:[0,1,0]
    v_cvt_pk_bf16_f32 v99, v50, v51
    v_cvt_pk_bf16_f32 v100, v54, v55
    v_cvt_pk_bf16_f32 v101, v58, v59
    v_cvt_pk_bf16_f32 v102, v62, v63
    v_pk_mul_f32 v[48:49], v[50:51], v[44:45] op_sel:[0,0] op_sel_hi:[1,0]
    v_pk_fma_f32 v[48:49], v[50:51], v[44:45], v[48:49] op_sel:[1,1,0] op_sel_hi:[0,1,1] neg_lo:[0,1,0]
    v_pk_mul_f32 v[56:57], v[58:59], v[44:45] op_sel:[0,0] op_sel_hi:[1,0]
    v_pk_fma_f32 v[56:57], v[58:59], v[44:45], v[56:57] op_sel:[1,1,0] op_sel_hi:[0,1,1] neg_lo:[0,1,0]
    v_cvt_pk_bf16_f32 v103, v48, v49
    v_cvt_pk_bf16_f32 v104, v56, v57
    v_pk_mul_f32 v[50:51], v[48:49], v[44:45] op_sel:[0,0] op_sel_hi:[1,0]
    v_pk_fma_f32 v[50:51], v[48:49], v[44:45], v[50:51] op_sel:[1,1,0] op_sel_hi:[0,1,1] neg_lo:[0,1,0]
    v_pk_mul_f32 v[58:59], v[56:57], v[44:45] op_sel:[0,0] op_sel_hi:[1,0]
    v_pk_fma_f32 v[58:59], v[56:57], v[44:45], v[58:59] op_sel:[1,1,0] op_sel_hi:[0,1,1] neg_lo:[0,1,0]
    v_cvt_pk_bf16_f32 v105, v50, v51
    v_cvt_pk_bf16_f32 v106, v58, v59
    v_pk_mul_f32 v[48:49], v[50:51], v[44:45] op_sel:[0,0] op_sel_hi:[1,0]
    v_pk_fma_f32 v[48:49], v[50:51], v[44:45], v[48:49] op_sel:[1,1,0] op_sel_hi:[0,1,1] neg_lo:[0,1,0]
    v_pk_mul_f32 v[56:57], v[58:59], v[44:45] op_sel:[0,0] op_sel_hi:[1,0]
    v_pk_fma_f32 v[56:57], v[58:59], v[44:45], v[56:57] op_sel:[1,1,0] op_sel_hi:[0,1,1] neg_lo:[0,1,0]
    v_cvt_pk_bf16_f32 v107, v48, v49
    v_cvt_pk_bf16_f32 v108, v56, v57
    v_pk_mul_f32 v[50:51], v[48:49], v[44:45] op_sel:[0,0] op_sel_hi:[1,0]
    v_pk_fma_f32 v[50:51], v[48:49], v[44:45], v[50:51] op_sel:[1,1,0] op_sel_hi:[0,1,1] neg_lo:[0,1,0]
    v_pk_mul_f32 v[58:59], v[56:57], v[44:45] op_sel:[0,0] op_sel_hi:[1,0]
    v_pk_fma_f32 v[58:59], v[56:57], v[44:45], v[58:59] op_sel:[1,1,0] op_sel_hi:[0,1,1] neg_lo:[0,1,0]
    v_cvt_pk_bf16_f32 v109, v50, v51
    v_cvt_pk_bf16_f32 v110, v58, v59
    v_pk_mul_f32 v[48:49], v[50:51], v[44:45] op_sel:[0,0] op_sel_hi:[1,0]
    v_pk_fma_f32 v[48:49], v[50:51], v[44:45], v[48:49] op_sel:[1,1,0] op_sel_hi:[0,1,1] neg_lo:[0,1,0]
    v_pk_mul_f32 v[50:51], v[48:49], v[44:45] op_sel:[0,0] op_sel_hi:[1,0]
    v_pk_fma_f32 v[50:51], v[48:49], v[44:45], v[50:51] op_sel:[1,1,0] op_sel_hi:[0,1,1] neg_lo:[0,1,0]
    v_cvt_pk_bf16_f32 v111, v48, v49
    v_pk_mul_f32 v[48:49], v[50:51], v[44:45] op_sel:[0,0] op_sel_hi:[1,0]
    v_pk_fma_f32 v[48:49], v[50:51], v[44:45], v[48:49] op_sel:[1,1,0] op_sel_hi:[0,1,1] neg_lo:[0,1,0]
    v_cvt_pk_bf16_f32 v112, v50, v51
    v_pk_mul_f32 v[50:51], v[48:49], v[44:45] op_sel:[0,0] op_sel_hi:[1,0]
    v_pk_fma_f32 v[50:51], v[48:49], v[44:45], v[50:51] op_sel:[1,1,0] op_sel_hi:[0,1,1] neg_lo:[0,1,0]
    v_cvt_pk_bf16_f32 v113, v48, v49
    v_pk_mul_f32 v[48:49], v[50:51], v[44:45] op_sel:[0,0] op_sel_hi:[1,0]
    v_pk_fma_f32 v[48:49], v[50:51], v[44:45], v[48:49] op_sel:[1,1,0] op_sel_hi:[0,1,1] neg_lo:[0,1,0]
    v_cvt_pk_bf16_f32 v114, v50, v51
    v_pk_mul_f32 v[50:51], v[48:49], v[44:45] op_sel:[0,0] op_sel_hi:[1,0]
    v_pk_fma_f32 v[50:51], v[48:49], v[44:45], v[50:51] op_sel:[1,1,0] op_sel_hi:[0,1,1] neg_lo:[0,1,0]
    v_cvt_pk_bf16_f32 v115, v48, v49
    v_pk_mul_f32 v[48:49], v[50:51], v[44:45] op_sel:[0,0] op_sel_hi:[1,0]
    v_pk_fma_f32 v[48:49], v[50:51], v[44:45], v[48:49] op_sel:[1,1,0] op_sel_hi:[0,1,1] neg_lo:[0,1,0]
    v_cvt_pk_bf16_f32 v116, v50, v51
    v_pk_mul_f32 v[50:51], v[48:49], v[44:45] op_sel:[0,0] op_sel_hi:[1,0]
    v_pk_fma_f32 v[50:51], v[48:49], v[44:45], v[50:51] op_sel:[1,1,0] op_sel_hi:[0,1,1] neg_lo:[0,1,0]
    v_cvt_pk_bf16_f32 v117, v48, v49
    v_pk_mul_f32 v[48:49], v[50:51], v[44:45] op_sel:[0,0] op_sel_hi:[1,0]
    v_pk_fma_f32 v[48:49], v[50:51], v[44:45], v[48:49] op_sel:[1,1,0] op_sel_hi:[0,1,1] neg_lo:[0,1,0]
    v_cvt_pk_bf16_f32 v118, v50, v51
    v_cvt_pk_bf16_f32 v119, v48, v49
    s_cmp_lg_u32 s14, 2
    s_cbranch_scc1 k_v1
    v_pk_mov_b32 v[120:121], v[64:65], v[64:65] op_sel:[0,1]
    v_pk_mov_b32 v[122:123], v[66:67], v[66:67] op_sel:[0,1]
    v_pk_mov_b32 v[124:125], v[68:69], v[68:69] op_sel:[0,1]
    v_pk_mov_b32 v[126:127], v[70:71], v[70:71] op_sel:[0,1]
    v_pk_mov_b32 v[128:129], v[72:73], v[72:73] op_sel:[0,1]
    v_pk_mov_b32 v[130:131], v[74:75], v[74:75] op_sel:[0,1]
    v_pk_mov_b32 v[132:133], v[76:77], v[76:77] op_sel:[0,1]
    v_pk_mov_b32 v[134:135], v[78:79], v[78:79] op_sel:[0,1]
    v_pk_mov_b32 v[136:137], v[80:81], v[80:81] op_sel:[0,1]
    v_pk_mov_b32 v[138:139], v[82:83], v[82:83] op_sel:[0,1]
    v_pk_mov_b32 v[140:141], v[84:85], v[84:85] op_sel:[0,1]
    v_pk_mov_b32 v[142:143], v[86:87], v[86:87] op_sel:[0,1]
    v_pk_mov_b32 v[144:145], v[88:89], v[88:89] op_sel:[0,1]
    v_pk_mov_b32 v[146:147], v[90:91], v[90:91] op_sel:[0,1]
    v_pk_mov_b32 v[148:149], v[92:93], v[92:93] op_sel:[0,1]
    v_pk_mov_b32 v[150:151], v[94:95], v[94:95] op_sel:[0,1]
    v_pk_mov_b32 v[152:153], v[96:97], v[96:97] op_sel:[0,1]
    v_pk_mov_b32 v[154:155], v[98:99], v[98:99] op_sel:[0,1]
    v_pk_mov_b32 v[156:157], v[100:101], v[100:101] op_sel:[0,1]
    v_pk_mov_b32 v[158:159], v[102:103], v[102:103] op_sel:[0,1]
    v_pk_mov_b32 v[160:161], v[104:105], v[104:105] op_sel:[0,1]
    v_pk_mov_b32 v[162:163], v[106:107], v[106:107] op_sel:[0,1]
    v_pk_mov_b32 v[164:165], v[108:109], v[108:109] op_sel:[0,1]
    v_pk_mov_b32 v[166:167], v[110:111], v[110:111] op_sel:[0,1]
    v_pk_mov_b32 v[168:169], v[112:113], v[112:113] op_sel:[0,1]
    v_pk_mov_b32 v[170:171], v[114:115], v[114:115] op_sel:[0,1]
    v_pk_mov_b32 v[172:173], v[116:117], v[116:117] op_sel:[0,1]
    v_pk_mov_b32 v[174:175], v[118:119], v[118:119] op_sel:[0,1]
    s_mov_b32 s14, 3
    s_branch k_loop
k_v1:
k_w:
    ds_write_addtid_b32 v36 offset:2176
    ds_write_addtid_b32 v64 offset:2720
    ds_write_addtid_b32 v65 offset:3264
    ds_write_addtid_b32 v66 offset:3808
    ds_write_addtid_b32 v67 offset:256
    ds_write_addtid_b32 v68 offset:800
    ds_write_addtid_b32 v69 offset:1344
    ds_write_addtid_b32 v70 offset:1888
    ds_write_addtid_b32 v71 offset:2432
    ds_write_addtid_b32 v72 offset:2976
    ds_write_addtid_b32 v73 offset:3520
    ds_write_addtid_b32 v74 offset:4064
    ds_write_addtid_b32 v75 offset:0
    ds_write_addtid_b32 v76 offset:544
    ds_write_addtid_b32 v77 offset:1088
    ds_write_addtid_b32 v78 offset:1632
    ds_read_b128 v[176:179], v16 offset:0
    ds_read_b128 v[180:183], v16 offset:64
    ds_read_b128 v[184:187], v16 offset:128
    ds_read_b128 v[188:191], v16 offset:192
    ds_write_addtid_b32 v79 offset:2176
    ds_write_addtid_b32 v80 offset:2720
    ds_write_addtid_b32 v81 offset:2976
    ds_write_addtid_b32 v82 offset:2432
    ds_write_addtid_b32 v83 offset:3264
    ds_write_addtid_b32 v84 offset:3808
    ds_write_addtid_b32 v85 offset:4064
    ds_write_addtid_b32 v86 offset:3520
    ds_write_addtid_b32 v87 offset:256
    ds_write_addtid_b32 v88 offset:800
    ds_write_addtid_b32 v89 offset:544
    ds_write_addtid_b32 v90 offset:0
    ds_write_addtid_b32 v91 offset:1344
    ds_write_addtid_b32 v92 offset:1888
    ds_write_addtid_b32 v93 offset:1632
    ds_write_addtid_b32 v94 offset:1088
    ds_read_b128 v[192:195], v16 offset:0
    ds_read_b128 v[196:199], v16 offset:64
    ds_read_b128 v[200:203], v16 offset:128
    ds_read_b128 v[204:207], v16 offset:192
    ds_write_addtid_b32 v95 offset:2176
    ds_write_addtid_b32 v96 offset:2720
    ds_write_addtid_b32 v97 offset:3264
    ds_write_addtid_b32 v98 offset:3808
    ds_write_addtid_b32 v99 offset:256
    ds_write_addtid_b32 v100 offset:800
    ds_write_addtid_b32 v101 offset:1344
    ds_write_addtid_b32 v102 offset:1888
    ds_write_addtid_b32 v103 offset:2432
    ds_write_addtid_b32 v104 offset:2976
    ds_write_addtid_b32 v105 offset:3520
    ds_write_addtid_b32 v106 offset:4064
    ds_write_addtid_b32 v107 offset:0
    ds_write_addtid_b32 v108 offset:544
    ds_write_addtid_b32 v109 offset:1088
    ds_write_addtid_b32 v110 offset:1632
    s_nop 0
    s_waitcnt lgkmcnt(14)
    v_mfma_f32_16x16x32_bf16 v[20:23], v[192:195], v[176:179], v[20:23]
    v_mfma_f32_16x16x32_bf16 v[20:23], v[196:199], v[180:183], v[20:23]
    v_mfma_f32_16x16x32_bf16 v[20:23], v[200:203], v[184:187], v[20:23]
    v_mfma_f32_16x16x32_bf16 v[20:23], v[204:207], v[188:191], v[20:23]
    ds_read_b128 v[208:211], v16 offset:0
    ds_read_b128 v[212:215], v16 offset:64
    ds_read_b128 v[216:219], v16 offset:128
    ds_read_b128 v[220:223], v16 offset:192
    ds_write_addtid_b32 v111 offset:2176
    ds_write_addtid_b32 v112 offset:2720
    ds_write_addtid_b32 v113 offset:3264
    ds_write_addtid_b32 v114 offset:3808
    ds_write_addtid_b32 v115 offset:256
    ds_write_addtid_b32 v116 offset:800
    ds_write_addtid_b32 v117 offset:1344
    ds_write_addtid_b32 v118 offset:1888
    ds_write_addtid_b32 v119 offset:2432
    ds_read_b128 v[224:227], v16 offset:0
    ds_read_b128 v[228:231], v16 offset:64
    ds_read_b128 v[232:235], v16 offset:128
    ds_read_b128 v[236:239], v16 offset:192
    s_waitcnt lgkmcnt(13)
    v_mfma_f32_16x16x32_bf16 v[24:27], v[208:211], v[176:179], v[24:27]
    v_mfma_f32_16x16x32_bf16 v[24:27], v[212:215], v[180:183], v[24:27]
    v_mfma_f32_16x16x32_bf16 v[24:27], v[216:219], v[184:187], v[24:27]
    v_mfma_f32_16x16x32_bf16 v[24:27], v[220:223], v[188:191], v[24:27]
    s_waitcnt lgkmcnt(0)
    v_mfma_f32_16x16x32_bf16 v[28:31], v[224:227], v[176:179], v[28:31]
    v_mfma_f32_16x16x32_bf16 v[28:31], v[228:231], v[180:183], v[28:31]
    v_mfma_f32_16x16x32_bf16 v[28:31], v[232:235], v[184:187], v[28:31]
    v_mfma_f32_16x16x32_bf16 v[28:31], v[236:239], v[188:191], v[28:31]
    s_cmp_lg_u32 s14, 3
    s_cbranch_scc1 k_w1
    v_pk_mov_b32 v[64:65], v[120:121], v[120:121] op_sel:[0,1]
    v_pk_mov_b32 v[66:67], v[122:123], v[122:123] op_sel:[0,1]
    v_pk_mov_b32 v[68:69], v[124:125], v[124:125] op_sel:[0,1]
    v_pk_mov_b32 v[70:71], v[126:127], v[126:127] op_sel:[0,1]
    v_pk_mov_b32 v[72:73], v[128:129], v[128:129] op_sel:[0,1]
    v_pk_mov_b32 v[74:75], v[130:131], v[130:131] op_sel:[0,1]
    v_pk_mov_b32 v[76:77], v[132:133], v[132:133] op_sel:[0,1]
    v_pk_mov_b32 v[78:79], v[134:135], v[134:135] op_sel:[0,1]
    v_pk_mov_b32 v[80:81], v[136:137], v[136:137] op_sel:[0,1]
    v_pk_mov_b32 v[82:83], v[138:139], v[138:139] op_sel:[0,1]
    v_pk_mov_b32 v[84:85], v[140:141], v[140:141] op_sel:[0,1]
    v_pk_mov_b32 v[86:87], v[142:143], v[142:143] op_sel:[0,1]
    v_pk_mov_b32 v[88:89], v[144:145], v[144:145] op_sel:[0,1]
    v_pk_mov_b32 v[90:91], v[146:147], v[146:147] op_sel:[0,1]
    v_pk_mov_b32 v[92:93], v[148:149], v[148:149] op_sel:[0,1]
    v_pk_mov_b32 v[94:95], v[150:151], v[150:151] op_sel:[0,1]
    v_pk_mov_b32 v[96:97], v[152:153], v[152:153] op_sel:[0,1]
    v_pk_mov_b32 v[98:99], v[154:155], v[154:155] op_sel:[0,1]
    v_pk_mov_b32 v[100:101], v[156:157], v[156:157] op_sel:[0,1]
    v_pk_mov_b32 v[102:103], v[158:159], v[158:159] op_sel:[0,1]
    v_pk_mov_b32 v[104:105], v[160:161], v[160:161] op_sel:[0,1]
    v_pk_mov_b32 v[106:107], v[162:163], v[162:163] op_sel:[0,1]
    v_pk_mov_b32 v[108:109], v[164:165], v[164:165] op_sel:[0,1]
    v_pk_mov_b32 v[110:111], v[166:167], v[166:167] op_sel:[0,1]
    v_pk_mov_b32 v[112:113], v[168:169], v[168:169] op_sel:[0,1]
    v_pk_mov_b32 v[114:115], v[170:171], v[170:171] op_sel:[0,1]
    v_pk_mov_b32 v[116:117], v[172:173], v[172:173] op_sel:[0,1]
    v_pk_mov_b32 v[118:119], v[174:175], v[174:175] op_sel:[0,1]
    s_mov_b32 s14, 0
    s_branch k_w
k_w1:
    s_cmp_ge_u32 s3, 4
    s_cbranch_scc1 k_h
    v_add_u32 v15, s19, v1
    s_nop 4
    ds_write_b128 v15, v[20:23] offset:0
    ds_write_b128 v15, v[24:27] offset:1024
    ds_write_b128 v15, v[28:31] offset:2048
    s_sub_u32 s24, s3, 1
    s_cmp_ge_u32 s24, 3
    s_cbranch_scc1 mt_2
    v_lshrrev_b32 v40, 3, v0
    v_and_b32_e64 v41, 7, v0
    v_mov_b32 v42, 162744
    s_mov_b32 s62, 0
lw_5:
    ds_read_b32 v43, v42 offset:0
    s_addk_i32 s62, 1
    s_waitcnt lgkmcnt(0)
    v_cmp_ne_u32 vcc, 0, v43
    s_cbranch_vccz lw_6
    s_sleep 1
    s_cmpk_lt_u32 s62, 0x7000
    s_cbranch_scc1 lw_5
lw_6:
    s_cmp_eq_u32 s3, 2
    s_cbranch_scc1 mt_3
    s_mov_b32 s24, s2
    s_mov_b32 s25, 82048
    s_cmp_eq_u32 s3, 1
    s_cbranch_scc1 mt_4
    v_lshlrev_b32 v42, 4, v41
    v_add_u32 v42, 106624, v42
    v_mul_u32_u24 v43, 1280, v40
    v_add_u32_e64 v43, v43, v42
    ds_read_b128 v[160:163], v43 offset:0
    ds_read_b128 v[200:203], v42 offset:10240
    ds_read_b128 v[164:167], v43 offset:128
    ds_read_b128 v[204:207], v42 offset:10368
    ds_read_b128 v[168:171], v43 offset:256
    ds_read_b128 v[208:211], v42 offset:10496
    ds_read_b128 v[172:175], v43 offset:384
    ds_read_b128 v[212:215], v42 offset:10624
    ds_read_b128 v[176:179], v43 offset:512
    ds_read_b128 v[216:219], v42 offset:10752
    ds_read_b128 v[180:183], v43 offset:640
    ds_read_b128 v[220:223], v42 offset:10880
    ds_read_b128 v[184:187], v43 offset:768
    ds_read_b128 v[224:227], v42 offset:11008
    ds_read_b128 v[188:191], v43 offset:896
    ds_read_b128 v[228:231], v42 offset:11136
    ds_read_b128 v[192:195], v43 offset:1024
    ds_read_b128 v[232:235], v42 offset:11264
    ds_read_b128 v[196:199], v43 offset:1152
    ds_read_b128 v[236:239], v42 offset:11392
    v_mov_b32 v44, 0
    v_mov_b32 v45, 0
    v_lshlrev_b32_e64 v46, 2, v0
    v_add_u32 v46, 163000, v46
    s_waitcnt lgkmcnt(0)
    v_dot2c_f32_bf16 v44, v160, v200
    v_dot2c_f32_bf16 v45, v161, v201
    v_dot2c_f32_bf16 v44, v162, v202
    v_dot2c_f32_bf16 v45, v163, v203
    v_dot2c_f32_bf16 v44, v164, v204
    v_dot2c_f32_bf16 v45, v165, v205
    v_dot2c_f32_bf16 v44, v166, v206
    v_dot2c_f32_bf16 v45, v167, v207
    v_dot2c_f32_bf16 v44, v168, v208
    v_dot2c_f32_bf16 v45, v169, v209
    v_dot2c_f32_bf16 v44, v170, v210
    v_dot2c_f32_bf16 v45, v171, v211
    v_dot2c_f32_bf16 v44, v172, v212
    v_dot2c_f32_bf16 v45, v173, v213
    v_dot2c_f32_bf16 v44, v174, v214
    v_dot2c_f32_bf16 v45, v175, v215
    v_dot2c_f32_bf16 v44, v176, v216
    v_dot2c_f32_bf16 v45, v177, v217
    v_dot2c_f32_bf16 v44, v178, v218
    v_dot2c_f32_bf16 v45, v179, v219
    v_dot2c_f32_bf16 v44, v180, v220
    v_dot2c_f32_bf16 v45, v181, v221
    v_dot2c_f32_bf16 v44, v182, v222
    v_dot2c_f32_bf16 v45, v183, v223
    v_dot2c_f32_bf16 v44, v184, v224
    v_dot2c_f32_bf16 v45, v185, v225
    v_dot2c_f32_bf16 v44, v186, v226
    v_dot2c_f32_bf16 v45, v187, v227
    v_dot2c_f32_bf16 v44, v188, v228
    v_dot2c_f32_bf16 v45, v189, v229
    v_dot2c_f32_bf16 v44, v190, v230
    v_dot2c_f32_bf16 v45, v191, v231
    v_dot2c_f32_bf16 v44, v192, v232
    v_dot2c_f32_bf16 v45, v193, v233
    v_dot2c_f32_bf16 v44, v194, v234
    v_dot2c_f32_bf16 v45, v195, v235
    v_dot2c_f32_bf16 v44, v196, v236
    v_dot2c_f32_bf16 v45, v197, v237
    v_dot2c_f32_bf16 v44, v198, v238
    v_dot2c_f32_bf16 v45, v199, v239
    s_lshr_b32 s24, s97, 1
    s_lshl_b32 s24, s24, 3
    s_add_u32 s24, s24, s96
    s_add_u32 s24, s24, 240
    s_and_b32 s25, s97, 1
    s_cselect_b32 s24, s24, 999
    s_mov_b32 s25, 98432
    s_cmp_ge_u32 s24, 320
    v_add_f32 v44, v44, v45
    ds_write_b32 v46, v44
    s_cbranch_scc1 mt_2
mt_4:
    s_cmp_ge_u32 s2, 240
    s_cbranch_scc1 mt_2
    v_xor_b32 v42, v40, v41
    v_lshlrev_b32 v42, 4, v42
    v_lshl_add_u32 v42, v41, 10, v42
    v_add_u32_e64 v42, s25, v42
    ds_read_b128 v[160:163], v42 offset:0
    ds_read_b128 v[164:167], v42 offset:128
    ds_read_b128 v[168:171], v42 offset:256
    ds_read_b128 v[172:175], v42 offset:384
    ds_read_b128 v[176:179], v42 offset:512
    ds_read_b128 v[180:183], v42 offset:640
    ds_read_b128 v[184:187], v42 offset:768
    ds_read_b128 v[188:191], v42 offset:896
    v_lshlrev_b32 v43, 15, v40
    v_lshlrev_b32 v41, 4, v41
    v_sub_u32_e64 v43, v43, v41
    v_add_u32 v43, 4080, v43
    s_mov_b32 s28, 0x05040100
    s_mov_b32 s29, 0x07060302
    s_lshr_b32 s25, s24, 5
    s_and_b32 s24, s24, 31
    s_lshl_b32 s25, s25, 18
    s_lshl_b32 s24, s24, 7
    s_sub_u32 s25, s25, s24
    s_add_u32 s25, s25, 6291456
    s_waitcnt lgkmcnt(0)
    v_perm_b32 v192, v184, v188, s28
    v_perm_b32 v193, v176, v180, s28
    v_perm_b32 v194, v168, v172, s28
    v_perm_b32 v195, v160, v164, s28
    buffer_store_dwordx4 v[192:195], v43, s[20:23], s25 offen sc1
    s_add_u32 s25, s25, 4096
    v_perm_b32 v196, v184, v188, s29
    v_perm_b32 v197, v176, v180, s29
    v_perm_b32 v198, v168, v172, s29
    v_perm_b32 v199, v160, v164, s29
    buffer_store_dwordx4 v[196:199], v43, s[20:23], s25 offen sc1
    s_add_u32 s25, s25, 4096
    v_perm_b32 v200, v185, v189, s28
    v_perm_b32 v201, v177, v181, s28
    v_perm_b32 v202, v169, v173, s28
    v_perm_b32 v203, v161, v165, s28
    buffer_store_dwordx4 v[200:203], v43, s[20:23], s25 offen sc1
    s_add_u32 s25, s25, 4096
    v_perm_b32 v204, v185, v189, s29
    v_perm_b32 v205, v177, v181, s29
    v_perm_b32 v206, v169, v173, s29
    v_perm_b32 v207, v161, v165, s29
    buffer_store_dwordx4 v[204:207], v43, s[20:23], s25 offen sc1
    s_add_u32 s25, s25, 4096
    v_perm_b32 v208, v186, v190, s28
    v_perm_b32 v209, v178, v182, s28
    v_perm_b32 v210, v170, v174, s28
    v_perm_b32 v211, v162, v166, s28
    buffer_store_dwordx4 v[208:211], v43, s[20:23], s25 offen sc1
    s_add_u32 s25, s25, 4096
    v_perm_b32 v212, v186, v190, s29
    v_perm_b32 v213, v178, v182, s29
    v_perm_b32 v214, v170, v174, s29
    v_perm_b32 v215, v162, v166, s29
    buffer_store_dwordx4 v[212:215], v43, s[20:23], s25 offen sc1
    s_add_u32 s25, s25, 4096
    v_perm_b32 v216, v187, v191, s28
    v_perm_b32 v217, v179, v183, s28
    v_perm_b32 v218, v171, v175, s28
    v_perm_b32 v219, v163, v167, s28
    buffer_store_dwordx4 v[216:219], v43, s[20:23], s25 offen sc1
    s_add_u32 s25, s25, 4096
    v_perm_b32 v220, v187, v191, s29
    v_perm_b32 v221, v179, v183, s29
    v_perm_b32 v222, v171, v175, s29
    v_perm_b32 v223, v163, v167, s29
    buffer_store_dwordx4 v[220:223], v43, s[20:23], s25 offen sc1
    s_add_u32 s25, s25, 4096
    s_branch mt_2
mt_3:
    s_cmp_ge_u32 s2, 240
    s_cbranch_scc1 mt_2
    v_lshrrev_b32 v42, 5, v0
    v_lshlrev_b32 v42, 11, v42
    v_bfe_u32 v43, v0, 2, 3
    v_lshl_add_u32 v42, v43, 7, v42
    v_and_b32_e64 v43, 3, v0
    v_lshl_add_u32 v42, v43, 3, v42
    v_add_u32 v42, 90240, v42
    ds_read_b64_tr_b16 v[160:161], v42 offset:0
    ds_read_b64_tr_b16 v[162:163], v42 offset:1024
    ds_read_b64_tr_b16 v[164:165], v42 offset:4096
    ds_read_b64_tr_b16 v[166:167], v42 offset:5120
    ds_read_b64_tr_b16 v[168:169], v42 offset:32
    ds_read_b64_tr_b16 v[170:171], v42 offset:1056
    ds_read_b64_tr_b16 v[172:173], v42 offset:4128
    ds_read_b64_tr_b16 v[174:175], v42 offset:5152
    ds_read_b64_tr_b16 v[176:177], v42 offset:64
    ds_read_b64_tr_b16 v[178:179], v42 offset:1088
    ds_read_b64_tr_b16 v[180:181], v42 offset:4160
    ds_read_b64_tr_b16 v[182:183], v42 offset:5184
    ds_read_b64_tr_b16 v[184:185], v42 offset:96
    ds_read_b64_tr_b16 v[186:187], v42 offset:1120
    ds_read_b64_tr_b16 v[188:189], v42 offset:4192
    ds_read_b64_tr_b16 v[190:191], v42 offset:5216
    s_mul_i32 s25, s2, 2731
    s_lshr_b32 s25, s25, 16
    s_mul_i32 s24, s25, 24
    s_sub_u32 s24, s2, s24
    s_mul_i32 s24, s24, 10
    s_lshl_b32 s25, s25, 2
    s_add_u32 s26, s25, 0
    s_mul_i32 s27, s26, 52429
    s_lshr_b32 s27, s27, 18
    s_mul_i32 s27, s27, 235
    s_add_u32 s26, s26, s27
    s_add_u32 s26, s26, s24
    s_lshl_b32 s26, s26, 10
    s_add_u32 s26, s26, 12582912
    s_add_u32 s27, s26, 5120
    s_waitcnt lgkmcnt(12)
    buffer_store_dwordx4 v[160:163], v1, s[20:23], s26 offen sc1
    buffer_store_dwordx4 v[164:167], v1, s[20:23], s27 offen sc1
    s_add_u32 s26, s25, 1
    s_mul_i32 s27, s26, 52429
    s_lshr_b32 s27, s27, 18
    s_mul_i32 s27, s27, 235
    s_add_u32 s26, s26, s27
    s_add_u32 s26, s26, s24
    s_lshl_b32 s26, s26, 10
    s_add_u32 s26, s26, 12582912
    s_add_u32 s27, s26, 5120
    s_waitcnt lgkmcnt(8)
    buffer_store_dwordx4 v[168:171], v1, s[20:23], s26 offen sc1
    buffer_store_dwordx4 v[172:175], v1, s[20:23], s27 offen sc1
    s_add_u32 s26, s25, 2
    s_mul_i32 s27, s26, 52429
    s_lshr_b32 s27, s27, 18
    s_mul_i32 s27, s27, 235
    s_add_u32 s26, s26, s27
    s_add_u32 s26, s26, s24
    s_lshl_b32 s26, s26, 10
    s_add_u32 s26, s26, 12582912
    s_add_u32 s27, s26, 5120
    s_waitcnt lgkmcnt(4)
    buffer_store_dwordx4 v[176:179], v1, s[20:23], s26 offen sc1
    buffer_store_dwordx4 v[180:183], v1, s[20:23], s27 offen sc1
    s_add_u32 s26, s25, 3
    s_mul_i32 s27, s26, 52429
    s_lshr_b32 s27, s27, 18
    s_mul_i32 s27, s27, 235
    s_add_u32 s26, s26, s27
    s_add_u32 s26, s26, s24
    s_lshl_b32 s26, s26, 10
    s_add_u32 s26, s26, 12582912
    s_add_u32 s27, s26, 5120
    s_waitcnt lgkmcnt(0)
    buffer_store_dwordx4 v[184:187], v1, s[20:23], s26 offen sc1
    buffer_store_dwordx4 v[188:191], v1, s[20:23], s27 offen sc1
mt_2:
    s_mov_b32 s16, 0xfffebf80
    s_mov_b32 s17, 41024
    s_mov_b32 s11, 0
    s_mov_b32 s12, 0
    s_mul_i32 s14, s7, 245760
    s_mul_i32 s15, s3, 61440
    s_add_u32 s14, s14, s15
    s_add_u32 s14, s14, 12582912
    s_and_b32 s18, s6, 1
    s_mul_i32 s15, s18, 30720
    s_add_u32 s14, s14, s15
    s_mul_i32 s15, s18, 24576
    s_add_u32 s53, s53, s15
    s_mul_i32 s15, s18, 49152
    s_sub_u32 s15, 4096, s15
    s_mul_i32 s18, s18, 61440
    s_sub_u32 s18, 2048, s18
    s_cmp_ge_u32 s2, 240
    s_waitcnt lgkmcnt(0)
    s_cbranch_scc1 k_ms
    s_barrier
    ds_read_b64_tr_b16 v[16:17], v6 offset:0
    ds_read_b64_tr_b16 v[18:19], v6 offset:512
    ds_read_b128 v[48:51], v2 offset:0
    ds_read_b128 v[52:55], v2 offset:2048
    ds_read_b64_tr_b16 v[20:21], v8 offset:0
    ds_read_b64_tr_b16 v[22:23], v8 offset:512
    ds_read_b64_tr_b16 v[24:25], v6 offset:8256
    ds_read_b128 v[56:59], v2 offset:4096
    ds_read_b64_tr_b16 v[26:27], v6 offset:8768
    ds_read_b64_tr_b16 v[28:29], v8 offset:8256
    ds_read_b64_tr_b16 v[30:31], v8 offset:8768
    ds_read_b128 v[60:63], v2 offset:6144
    ds_read_b128 v[248:251], v2 offset:8192
    ds_read_b128 v[252:255], v2 offset:10240
    s_waitcnt lgkmcnt(3)
    v_mfma_f32_16x16x32_bf16 v[64:67], v[16:19], v[48:51], 0
    s_add_u32 s12, s12, 1
    v_mfma_f32_16x16x32_bf16 v[68:71], v[20:23], v[48:51], 0
    s_cmp_eq_u32 s12, 3
    v_mfma_f32_16x16x32_bf16 v[72:75], v[24:27], v[48:51], 0
    s_cselect_b32 s13, s16, s17
    v_mfma_f32_16x16x32_bf16 v[76:79], v[28:31], v[48:51], 0
    ds_read_b128 v[48:51], v3 offset:0
    v_mfma_f32_16x16x32_bf16 v[112:115], v[16:19], v[52:55], 0
    ds_read_b64_tr_b16 v[32:33], v6 offset:4096
    v_mfma_f32_16x16x32_bf16 v[116:119], v[20:23], v[52:55], 0
    ds_read_b64_tr_b16 v[34:35], v6 offset:4608
    v_mfma_f32_16x16x32_bf16 v[120:123], v[24:27], v[52:55], 0
    ds_read_b64_tr_b16 v[36:37], v8 offset:4096
    v_mfma_f32_16x16x32_bf16 v[124:127], v[28:31], v[52:55], 0
    ds_read_b128 v[52:55], v3 offset:2048
    v_mfma_f32_16x16x32_bf16 v[80:83], v[16:19], v[56:59], 0
    ds_read_b64_tr_b16 v[38:39], v8 offset:4608
    v_mfma_f32_16x16x32_bf16 v[84:87], v[20:23], v[56:59], 0
    ds_read_b64_tr_b16 v[40:41], v6 offset:12352
    v_mfma_f32_16x16x32_bf16 v[88:91], v[24:27], v[56:59], 0
    ds_read_b64_tr_b16 v[42:43], v6 offset:12864
    v_mfma_f32_16x16x32_bf16 v[92:95], v[28:31], v[56:59], 0
    ds_read_b128 v[56:59], v3 offset:4096
    s_waitcnt lgkmcnt(11)
    v_mfma_f32_16x16x32_bf16 v[128:131], v[16:19], v[60:63], 0
    ds_read_b64_tr_b16 v[44:45], v8 offset:12352
    v_mfma_f32_16x16x32_bf16 v[132:135], v[20:23], v[60:63], 0
    ds_read_b64_tr_b16 v[46:47], v8 offset:12864
    v_mfma_f32_16x16x32_bf16 v[136:139], v[24:27], v[60:63], 0
    s_cselect_b32 s12, 0, s12
    v_mfma_f32_16x16x32_bf16 v[140:143], v[28:31], v[60:63], 0
    ds_read_b128 v[60:63], v3 offset:6144
    s_waitcnt lgkmcnt(13)
    v_mfma_f32_16x16x32_bf16 v[96:99], v[16:19], v[248:251], 0
    v_add_u32 v2, s13, v2
    v_mfma_f32_16x16x32_bf16 v[100:103], v[20:23], v[248:251], 0
    v_add_u32_e64 v6, s13, v6
    v_mfma_f32_16x16x32_bf16 v[104:107], v[24:27], v[248:251], 0
    v_add_u32_e64 v8, s13, v8
    v_mfma_f32_16x16x32_bf16 v[108:111], v[28:31], v[248:251], 0
    ds_read_b128 v[248:251], v3 offset:8192
    s_waitcnt lgkmcnt(13)
    v_mfma_f32_16x16x32_bf16 v[144:147], v[16:19], v[252:255], 0
    s_add_u32 s11, s11, 1
    v_mfma_f32_16x16x32_bf16 v[148:151], v[20:23], v[252:255], 0
    v_mfma_f32_16x16x32_bf16 v[152:155], v[24:27], v[252:255], 0
    v_mfma_f32_16x16x32_bf16 v[156:159], v[28:31], v[252:255], 0
    ds_read_b128 v[252:255], v3 offset:10240
    s_branch g1e_8
g1_7:
    s_waitcnt lgkmcnt(3)
    v_mfma_f32_16x16x32_bf16 v[64:67], v[16:19], v[48:51], v[64:67]
    s_add_u32 s12, s12, 1
    v_mfma_f32_16x16x32_bf16 v[68:71], v[20:23], v[48:51], v[68:71]
    s_cmp_eq_u32 s12, 3
    v_mfma_f32_16x16x32_bf16 v[72:75], v[24:27], v[48:51], v[72:75]
    s_cselect_b32 s13, s16, s17
    s_nop 0
    v_mfma_f32_16x16x32_bf16 v[76:79], v[28:31], v[48:51], v[76:79]
    ds_read_b128 v[48:51], v3 offset:0
    v_mfma_f32_16x16x32_bf16 v[112:115], v[16:19], v[52:55], v[112:115]
    ds_read_b64_tr_b16 v[32:33], v6 offset:4096
    v_mfma_f32_16x16x32_bf16 v[116:119], v[20:23], v[52:55], v[116:119]
    ds_read_b64_tr_b16 v[34:35], v6 offset:4608
    v_mfma_f32_16x16x32_bf16 v[120:123], v[24:27], v[52:55], v[120:123]
    ds_read_b64_tr_b16 v[36:37], v8 offset:4096
    v_mfma_f32_16x16x32_bf16 v[124:127], v[28:31], v[52:55], v[124:127]
    ds_read_b128 v[52:55], v3 offset:2048
    v_mfma_f32_16x16x32_bf16 v[80:83], v[16:19], v[56:59], v[80:83]
    ds_read_b64_tr_b16 v[38:39], v8 offset:4608
    v_mfma_f32_16x16x32_bf16 v[84:87], v[20:23], v[56:59], v[84:87]
    ds_read_b64_tr_b16 v[40:41], v6 offset:12352
    v_mfma_f32_16x16x32_bf16 v[88:91], v[24:27], v[56:59], v[88:91]
    ds_read_b64_tr_b16 v[42:43], v6 offset:12864
    v_mfma_f32_16x16x32_bf16 v[92:95], v[28:31], v[56:59], v[92:95]
    ds_read_b128 v[56:59], v3 offset:4096
    s_waitcnt lgkmcnt(11)
    v_mfma_f32_16x16x32_bf16 v[128:131], v[16:19], v[60:63], v[128:131]
    ds_read_b64_tr_b16 v[44:45], v8 offset:12352
    v_mfma_f32_16x16x32_bf16 v[132:135], v[20:23], v[60:63], v[132:135]
    ds_read_b64_tr_b16 v[46:47], v8 offset:12864
    v_mfma_f32_16x16x32_bf16 v[136:139], v[24:27], v[60:63], v[136:139]
    s_cselect_b32 s12, 0, s12
    v_mfma_f32_16x16x32_bf16 v[140:143], v[28:31], v[60:63], v[140:143]
    ds_read_b128 v[60:63], v3 offset:6144
    s_waitcnt lgkmcnt(13)
    v_mfma_f32_16x16x32_bf16 v[96:99], v[16:19], v[248:251], v[96:99]
    v_add_u32 v2, s13, v2
    v_mfma_f32_16x16x32_bf16 v[100:103], v[20:23], v[248:251], v[100:103]
    v_add_u32_e64 v6, s13, v6
    v_mfma_f32_16x16x32_bf16 v[104:107], v[24:27], v[248:251], v[104:107]
    v_add_u32_e64 v8, s13, v8
    v_mfma_f32_16x16x32_bf16 v[108:111], v[28:31], v[248:251], v[108:111]
    ds_read_b128 v[248:251], v3 offset:8192
    s_waitcnt lgkmcnt(13)
    v_mfma_f32_16x16x32_bf16 v[144:147], v[16:19], v[252:255], v[144:147]
    s_add_u32 s11, s11, 1
    v_mfma_f32_16x16x32_bf16 v[148:151], v[20:23], v[252:255], v[148:151]
    v_mfma_f32_16x16x32_bf16 v[152:155], v[24:27], v[252:255], v[152:155]
    v_mfma_f32_16x16x32_bf16 v[156:159], v[28:31], v[252:255], v[156:159]
    ds_read_b128 v[252:255], v3 offset:10240
g1e_8:
    s_waitcnt lgkmcnt(3)
    v_mfma_f32_16x16x32_bf16 v[64:67], v[32:35], v[48:51], v[64:67]
    v_add_u32 v3, s13, v3
    v_mfma_f32_16x16x32_bf16 v[68:71], v[36:39], v[48:51], v[68:71]
    s_waitcnt vmcnt(0)
    v_mfma_f32_16x16x32_bf16 v[72:75], v[40:43], v[48:51], v[72:75]
    v_mfma_f32_16x16x32_bf16 v[76:79], v[44:47], v[48:51], v[76:79]
    v_mfma_f32_16x16x32_bf16 v[112:115], v[32:35], v[52:55], v[112:115]
    s_waitcnt lgkmcnt(0)
    s_nop 0
    s_barrier
    ds_read_b64_tr_b16 v[16:17], v6 offset:0
    v_mfma_f32_16x16x32_bf16 v[116:119], v[36:39], v[52:55], v[116:119]
    ds_read_b64_tr_b16 v[18:19], v6 offset:512
    v_mfma_f32_16x16x32_bf16 v[120:123], v[40:43], v[52:55], v[120:123]
    ds_read_b128 v[48:51], v2 offset:0
    v_mfma_f32_16x16x32_bf16 v[124:127], v[44:47], v[52:55], v[124:127]
    ds_read_b128 v[52:55], v2 offset:2048
    v_mfma_f32_16x16x32_bf16 v[80:83], v[32:35], v[56:59], v[80:83]
    ds_read_b64_tr_b16 v[20:21], v8 offset:0
    v_mfma_f32_16x16x32_bf16 v[84:87], v[36:39], v[56:59], v[84:87]
    ds_read_b64_tr_b16 v[22:23], v8 offset:512
    v_mfma_f32_16x16x32_bf16 v[88:91], v[40:43], v[56:59], v[88:91]
    ds_read_b64_tr_b16 v[24:25], v6 offset:8256
    v_mfma_f32_16x16x32_bf16 v[92:95], v[44:47], v[56:59], v[92:95]
    ds_read_b128 v[56:59], v2 offset:4096
    v_mfma_f32_16x16x32_bf16 v[128:131], v[32:35], v[60:63], v[128:131]
    ds_read_b64_tr_b16 v[26:27], v6 offset:8768
    v_mfma_f32_16x16x32_bf16 v[132:135], v[36:39], v[60:63], v[132:135]
    ds_read_b64_tr_b16 v[28:29], v8 offset:8256
    v_mfma_f32_16x16x32_bf16 v[136:139], v[40:43], v[60:63], v[136:139]
    ds_read_b64_tr_b16 v[30:31], v8 offset:8768
    v_mfma_f32_16x16x32_bf16 v[140:143], v[44:47], v[60:63], v[140:143]
    ds_read_b128 v[60:63], v2 offset:6144
    v_mfma_f32_16x16x32_bf16 v[96:99], v[32:35], v[248:251], v[96:99]
    v_mfma_f32_16x16x32_bf16 v[100:103], v[36:39], v[248:251], v[100:103]
    v_mfma_f32_16x16x32_bf16 v[104:107], v[40:43], v[248:251], v[104:107]
    v_mfma_f32_16x16x32_bf16 v[108:111], v[44:47], v[248:251], v[108:111]
    ds_read_b128 v[248:251], v2 offset:8192
    v_mfma_f32_16x16x32_bf16 v[144:147], v[32:35], v[252:255], v[144:147]
    v_mfma_f32_16x16x32_bf16 v[148:151], v[36:39], v[252:255], v[148:151]
    v_mfma_f32_16x16x32_bf16 v[152:155], v[40:43], v[252:255], v[152:155]
    s_cmp_lt_u32 s11, 7
    v_mfma_f32_16x16x32_bf16 v[156:159], v[44:47], v[252:255], v[156:159]
    ds_read_b128 v[252:255], v2 offset:10240
    s_cbranch_scc1 g1_7
    s_nop 0
    s_waitcnt lgkmcnt(3)
    v_mfma_f32_16x16x32_bf16 v[64:67], v[16:19], v[48:51], v[64:67]
    v_mfma_f32_16x16x32_bf16 v[68:71], v[20:23], v[48:51], v[68:71]
    v_mfma_f32_16x16x32_bf16 v[72:75], v[24:27], v[48:51], v[72:75]
    v_mfma_f32_16x16x32_bf16 v[76:79], v[28:31], v[48:51], v[76:79]
    ds_read_b128 v[48:51], v3 offset:0
    v_mfma_f32_16x16x32_bf16 v[112:115], v[16:19], v[52:55], v[112:115]
    ds_read_b64_tr_b16 v[32:33], v6 offset:4096
    v_mfma_f32_16x16x32_bf16 v[116:119], v[20:23], v[52:55], v[116:119]
    ds_read_b64_tr_b16 v[34:35], v6 offset:4608
    v_mfma_f32_16x16x32_bf16 v[120:123], v[24:27], v[52:55], v[120:123]
    ds_read_b64_tr_b16 v[36:37], v8 offset:4096
    v_mfma_f32_16x16x32_bf16 v[124:127], v[28:31], v[52:55], v[124:127]
    ds_read_b128 v[52:55], v3 offset:2048
    v_mfma_f32_16x16x32_bf16 v[80:83], v[16:19], v[56:59], v[80:83]
    ds_read_b64_tr_b16 v[38:39], v8 offset:4608
    v_mfma_f32_16x16x32_bf16 v[84:87], v[20:23], v[56:59], v[84:87]
    ds_read_b64_tr_b16 v[40:41], v6 offset:12352
    v_mfma_f32_16x16x32_bf16 v[88:91], v[24:27], v[56:59], v[88:91]
    ds_read_b64_tr_b16 v[42:43], v6 offset:12864
    v_mfma_f32_16x16x32_bf16 v[92:95], v[28:31], v[56:59], v[92:95]
    ds_read_b128 v[56:59], v3 offset:4096
    s_waitcnt lgkmcnt(11)
    v_mfma_f32_16x16x32_bf16 v[128:131], v[16:19], v[60:63], v[128:131]
    ds_read_b64_tr_b16 v[44:45], v8 offset:12352
    v_mfma_f32_16x16x32_bf16 v[132:135], v[20:23], v[60:63], v[132:135]
    ds_read_b64_tr_b16 v[46:47], v8 offset:12864
    v_mfma_f32_16x16x32_bf16 v[136:139], v[24:27], v[60:63], v[136:139]
    v_subrev_u32 v7, 8, v7
    v_mfma_f32_16x16x32_bf16 v[140:143], v[28:31], v[60:63], v[140:143]
    ds_read_b128 v[60:63], v3 offset:6144
    s_waitcnt lgkmcnt(13)
    v_mfma_f32_16x16x32_bf16 v[96:99], v[16:19], v[248:251], v[96:99]
    v_add_u32 v2, s17, v2
    v_mfma_f32_16x16x32_bf16 v[100:103], v[20:23], v[248:251], v[100:103]
    v_add_u32_e64 v6, s17, v6
    v_mfma_f32_16x16x32_bf16 v[104:107], v[24:27], v[248:251], v[104:107]
    v_add_u32_e64 v8, s17, v8
    v_mfma_f32_16x16x32_bf16 v[108:111], v[28:31], v[248:251], v[108:111]
    ds_read_b128 v[248:251], v3 offset:8192
    s_waitcnt lgkmcnt(13)
    v_mfma_f32_16x16x32_bf16 v[144:147], v[16:19], v[252:255], v[144:147]
    v_mfma_f32_16x16x32_bf16 v[148:151], v[20:23], v[252:255], v[148:151]
    v_mfma_f32_16x16x32_bf16 v[152:155], v[24:27], v[252:255], v[152:155]
    ds_read_b32 v13, v7 offset:4
    v_mfma_f32_16x16x32_bf16 v[156:159], v[28:31], v[252:255], v[156:159]
    ds_read_b128 v[252:255], v3 offset:10240
    s_waitcnt lgkmcnt(4)
    v_mfma_f32_16x16x32_bf16 v[64:67], v[32:35], v[48:51], v[64:67]
    v_add_u32_e64 v3, s17, v3
    v_mfma_f32_16x16x32_bf16 v[68:71], v[36:39], v[48:51], v[68:71]
    v_mfma_f32_16x16x32_bf16 v[72:75], v[40:43], v[48:51], v[72:75]
    v_mfma_f32_16x16x32_bf16 v[76:79], v[44:47], v[48:51], v[76:79]
    v_mfma_f32_16x16x32_bf16 v[112:115], v[32:35], v[52:55], v[112:115]
    s_waitcnt lgkmcnt(1)
    v_cmp_ne_u32 vcc, 0, v13
    s_nop 0
    s_cbranch_vccnz g1s_9
g1b_10:
    ds_read_b64_tr_b16 v[16:17], v6 offset:0
    v_mfma_f32_16x16x32_bf16 v[116:119], v[36:39], v[52:55], v[116:119]
    ds_read_b64_tr_b16 v[18:19], v6 offset:512
    v_mfma_f32_16x16x32_bf16 v[120:123], v[40:43], v[52:55], v[120:123]
    ds_read_b128 v[48:51], v2 offset:0
    v_mfma_f32_16x16x32_bf16 v[124:127], v[44:47], v[52:55], v[124:127]
    ds_read_b128 v[52:55], v2 offset:2048
    v_mfma_f32_16x16x32_bf16 v[80:83], v[32:35], v[56:59], v[80:83]
    ds_read_b64_tr_b16 v[20:21], v8 offset:0
    v_mfma_f32_16x16x32_bf16 v[84:87], v[36:39], v[56:59], v[84:87]
    ds_read_b64_tr_b16 v[22:23], v8 offset:512
    v_mfma_f32_16x16x32_bf16 v[88:91], v[40:43], v[56:59], v[88:91]
    ds_read_b64_tr_b16 v[24:25], v6 offset:8256
    v_mfma_f32_16x16x32_bf16 v[92:95], v[44:47], v[56:59], v[92:95]
    ds_read_b128 v[56:59], v2 offset:4096
    v_mfma_f32_16x16x32_bf16 v[128:131], v[32:35], v[60:63], v[128:131]
    ds_read_b64_tr_b16 v[26:27], v6 offset:8768
    v_mfma_f32_16x16x32_bf16 v[132:135], v[36:39], v[60:63], v[132:135]
    ds_read_b64_tr_b16 v[28:29], v8 offset:8256
    v_mfma_f32_16x16x32_bf16 v[136:139], v[40:43], v[60:63], v[136:139]
    ds_read_b64_tr_b16 v[30:31], v8 offset:8768
    v_mfma_f32_16x16x32_bf16 v[140:143], v[44:47], v[60:63], v[140:143]
    ds_read_b128 v[60:63], v2 offset:6144
    v_mfma_f32_16x16x32_bf16 v[96:99], v[32:35], v[248:251], v[96:99]
    v_mfma_f32_16x16x32_bf16 v[100:103], v[36:39], v[248:251], v[100:103]
    v_mfma_f32_16x16x32_bf16 v[104:107], v[40:43], v[248:251], v[104:107]
    v_mfma_f32_16x16x32_bf16 v[108:111], v[44:47], v[248:251], v[108:111]
    ds_read_b128 v[248:251], v2 offset:8192
    s_waitcnt lgkmcnt(13)
    v_mfma_f32_16x16x32_bf16 v[144:147], v[32:35], v[252:255], v[144:147]
    v_mfma_f32_16x16x32_bf16 v[148:151], v[36:39], v[252:255], v[148:151]
    v_mfma_f32_16x16x32_bf16 v[152:155], v[40:43], v[252:255], v[152:155]
    v_mfma_f32_16x16x32_bf16 v[156:159], v[44:47], v[252:255], v[156:159]
    ds_read_b128 v[252:255], v2 offset:10240
    s_waitcnt lgkmcnt(3)
    v_mfma_f32_16x16x32_bf16 v[64:67], v[16:19], v[48:51], v[64:67]
    ds_read_b32 v12, v7
    v_mfma_f32_16x16x32_bf16 v[68:71], v[20:23], v[48:51], v[68:71]
    v_mfma_f32_16x16x32_bf16 v[72:75], v[24:27], v[48:51], v[72:75]
    v_mfma_f32_16x16x32_bf16 v[76:79], v[28:31], v[48:51], v[76:79]
    ds_read_b128 v[48:51], v3 offset:0
    v_mfma_f32_16x16x32_bf16 v[112:115], v[16:19], v[52:55], v[112:115]
    s_waitcnt lgkmcnt(1)
    v_cmp_ne_u32 vcc, 0, v12
    s_nop 0
    s_cbranch_vccnz g1s_11
g1b_12:
    ds_read_b64_tr_b16 v[32:33], v6 offset:4096
    v_mfma_f32_16x16x32_bf16 v[116:119], v[20:23], v[52:55], v[116:119]
    ds_read_b64_tr_b16 v[34:35], v6 offset:4608
    v_mfma_f32_16x16x32_bf16 v[120:123], v[24:27], v[52:55], v[120:123]
    ds_read_b64_tr_b16 v[36:37], v8 offset:4096
    v_mfma_f32_16x16x32_bf16 v[124:127], v[28:31], v[52:55], v[124:127]
    ds_read_b128 v[52:55], v3 offset:2048
    v_mfma_f32_16x16x32_bf16 v[80:83], v[16:19], v[56:59], v[80:83]
    ds_read_b64_tr_b16 v[38:39], v8 offset:4608
    v_mfma_f32_16x16x32_bf16 v[84:87], v[20:23], v[56:59], v[84:87]
    ds_read_b64_tr_b16 v[40:41], v6 offset:12352
    v_mfma_f32_16x16x32_bf16 v[88:91], v[24:27], v[56:59], v[88:91]
    ds_read_b64_tr_b16 v[42:43], v6 offset:12864
    v_mfma_f32_16x16x32_bf16 v[92:95], v[28:31], v[56:59], v[92:95]
    ds_read_b128 v[56:59], v3 offset:4096
    v_mfma_f32_16x16x32_bf16 v[128:131], v[16:19], v[60:63], v[128:131]
    ds_read_b64_tr_b16 v[44:45], v8 offset:12352
    v_mfma_f32_16x16x32_bf16 v[132:135], v[20:23], v[60:63], v[132:135]
    ds_read_b64_tr_b16 v[46:47], v8 offset:12864
    v_mfma_f32_16x16x32_bf16 v[136:139], v[24:27], v[60:63], v[136:139]
    v_subrev_u32_e64 v7, 8, v7
    v_mfma_f32_16x16x32_bf16 v[140:143], v[28:31], v[60:63], v[140:143]
    ds_read_b128 v[60:63], v3 offset:6144
    v_mfma_f32_16x16x32_bf16 v[96:99], v[16:19], v[248:251], v[96:99]
    v_add_u32_e64 v2, s16, v2
    v_mfma_f32_16x16x32_bf16 v[100:103], v[20:23], v[248:251], v[100:103]
    v_add_u32_e64 v6, s16, v6
    v_mfma_f32_16x16x32_bf16 v[104:107], v[24:27], v[248:251], v[104:107]
    v_add_u32_e64 v8, s16, v8
    v_mfma_f32_16x16x32_bf16 v[108:111], v[28:31], v[248:251], v[108:111]
    ds_read_b128 v[248:251], v3 offset:8192
    v_mfma_f32_16x16x32_bf16 v[144:147], v[16:19], v[252:255], v[144:147]
    v_mfma_f32_16x16x32_bf16 v[148:151], v[20:23], v[252:255], v[148:151]
    v_mfma_f32_16x16x32_bf16 v[152:155], v[24:27], v[252:255], v[152:155]
    ds_read_b32 v13, v7 offset:4
    v_mfma_f32_16x16x32_bf16 v[156:159], v[28:31], v[252:255], v[156:159]
    ds_read_b128 v[252:255], v3 offset:10240
    s_waitcnt lgkmcnt(4)
    v_mfma_f32_16x16x32_bf16 v[64:67], v[32:35], v[48:51], v[64:67]
    v_add_u32 v3, s16, v3
    v_mfma_f32_16x16x32_bf16 v[68:71], v[36:39], v[48:51], v[68:71]
    buffer_load_dwordx4 v[160:163], v1, s[20:23], s14 offen offset:0 sc1
    v_mfma_f32_16x16x32_bf16 v[72:75], v[40:43], v[48:51], v[72:75]
    v_mfma_f32_16x16x32_bf16 v[76:79], v[44:47], v[48:51], v[76:79]
    v_mfma_f32_16x16x32_bf16 v[112:115], v[32:35], v[52:55], v[112:115]
    s_waitcnt lgkmcnt(1)
    v_cmp_ne_u32 vcc, 0, v13
    s_nop 0
    s_cbranch_vccnz g1s_13
g1b_14:
    ds_read_b64_tr_b16 v[16:17], v6 offset:0
    v_mfma_f32_16x16x32_bf16 v[116:119], v[36:39], v[52:55], v[116:119]
    ds_read_b64_tr_b16 v[18:19], v6 offset:512
    buffer_load_dwordx4 v[164:167], v1, s[20:23], s14 offen offset:1024 sc1
    v_mfma_f32_16x16x32_bf16 v[120:123], v[40:43], v[52:55], v[120:123]
    ds_read_b128 v[48:51], v2 offset:0
    buffer_load_dwordx4 v[168:171], v1, s[20:23], s14 offen offset:2048 sc1
    v_mfma_f32_16x16x32_bf16 v[124:127], v[44:47], v[52:55], v[124:127]
    ds_read_b128 v[52:55], v2 offset:2048
    v_mfma_f32_16x16x32_bf16 v[80:83], v[32:35], v[56:59], v[80:83]
    ds_read_b64_tr_b16 v[20:21], v8 offset:0
    v_mfma_f32_16x16x32_bf16 v[84:87], v[36:39], v[56:59], v[84:87]
    ds_read_b64_tr_b16 v[22:23], v8 offset:512
    buffer_load_dwordx4 v[172:175], v1, s[20:23], s14 offen offset:3072 sc1
    s_add_u32 s14, s14, 4096
    v_mfma_f32_16x16x32_bf16 v[88:91], v[40:43], v[56:59], v[88:91]
    ds_read_b64_tr_b16 v[24:25], v6 offset:8256
    v_mfma_f32_16x16x32_bf16 v[92:95], v[44:47], v[56:59], v[92:95]
    ds_read_b128 v[56:59], v2 offset:4096
    v_mfma_f32_16x16x32_bf16 v[128:131], v[32:35], v[60:63], v[128:131]
    ds_read_b64_tr_b16 v[26:27], v6 offset:8768
    v_mfma_f32_16x16x32_bf16 v[132:135], v[36:39], v[60:63], v[132:135]
    ds_read_b64_tr_b16 v[28:29], v8 offset:8256
    buffer_load_dwordx4 v[176:179], v1, s[20:23], s14 offen offset:0 sc1
    v_mfma_f32_16x16x32_bf16 v[136:139], v[40:43], v[60:63], v[136:139]
    ds_read_b64_tr_b16 v[30:31], v8 offset:8768
    v_mfma_f32_16x16x32_bf16 v[140:143], v[44:47], v[60:63], v[140:143]
    ds_read_b128 v[60:63], v2 offset:6144
    v_mfma_f32_16x16x32_bf16 v[96:99], v[32:35], v[248:251], v[96:99]
    v_mfma_f32_16x16x32_bf16 v[100:103], v[36:39], v[248:251], v[100:103]
    buffer_load_dwordx4 v[180:183], v1, s[20:23], s14 offen offset:1024 sc1
    v_mfma_f32_16x16x32_bf16 v[104:107], v[40:43], v[248:251], v[104:107]
    buffer_load_dwordx4 v[184:187], v1, s[20:23], s14 offen offset:2048 sc1
    v_mfma_f32_16x16x32_bf16 v[108:111], v[44:47], v[248:251], v[108:111]
    ds_read_b128 v[248:251], v2 offset:8192
    s_waitcnt lgkmcnt(13)
    v_mfma_f32_16x16x32_bf16 v[144:147], v[32:35], v[252:255], v[144:147]
    v_mfma_f32_16x16x32_bf16 v[148:151], v[36:39], v[252:255], v[148:151]
    buffer_load_dwordx4 v[188:191], v1, s[20:23], s14 offen offset:3072 sc1
    s_add_u32 s14, s14, 4096
    v_mfma_f32_16x16x32_bf16 v[152:155], v[40:43], v[252:255], v[152:155]
    v_mfma_f32_16x16x32_bf16 v[156:159], v[44:47], v[252:255], v[156:159]
    ds_read_b128 v[252:255], v2 offset:10240
    s_waitcnt lgkmcnt(3)
    v_mfma_f32_16x16x32_bf16 v[64:67], v[16:19], v[48:51], v[64:67]
    ds_read_b32 v12, v7
    v_mfma_f32_16x16x32_bf16 v[68:71], v[20:23], v[48:51], v[68:71]
    buffer_load_dwordx4 v[192:195], v1, s[20:23], s14 offen offset:0 sc1
    v_mfma_f32_16x16x32_bf16 v[72:75], v[24:27], v[48:51], v[72:75]
    v_mfma_f32_16x16x32_bf16 v[76:79], v[28:31], v[48:51], v[76:79]
    ds_read_b128 v[48:51], v3 offset:0
    v_mfma_f32_16x16x32_bf16 v[112:115], v[16:19], v[52:55], v[112:115]
    s_waitcnt lgkmcnt(1)
    v_cmp_ne_u32 vcc, 0, v12
    s_nop 0
    s_cbranch_vccnz g1s_15
g1b_16:
    ds_read_b64_tr_b16 v[32:33], v6 offset:4096
    v_mfma_f32_16x16x32_bf16 v[116:119], v[20:23], v[52:55], v[116:119]
    ds_read_b64_tr_b16 v[34:35], v6 offset:4608
    buffer_load_dwordx4 v[196:199], v1, s[20:23], s14 offen offset:1024 sc1
    v_mfma_f32_16x16x32_bf16 v[120:123], v[24:27], v[52:55], v[120:123]
    ds_read_b64_tr_b16 v[36:37], v8 offset:4096
    buffer_load_dwordx4 v[200:203], v1, s[20:23], s14 offen offset:2048 sc1
    v_mfma_f32_16x16x32_bf16 v[124:127], v[28:31], v[52:55], v[124:127]
    ds_read_b128 v[52:55], v3 offset:2048
    v_mfma_f32_16x16x32_bf16 v[80:83], v[16:19], v[56:59], v[80:83]
    ds_read_b64_tr_b16 v[38:39], v8 offset:4608
    v_mfma_f32_16x16x32_bf16 v[84:87], v[20:23], v[56:59], v[84:87]
    ds_read_b64_tr_b16 v[40:41], v6 offset:12352
    buffer_load_dwordx4 v[204:207], v1, s[20:23], s14 offen offset:3072 sc1
    s_add_u32 s14, s14, 4096
    v_mfma_f32_16x16x32_bf16 v[88:91], v[24:27], v[56:59], v[88:91]
    ds_read_b64_tr_b16 v[42:43], v6 offset:12864
    v_mfma_f32_16x16x32_bf16 v[92:95], v[28:31], v[56:59], v[92:95]
    ds_read_b128 v[56:59], v3 offset:4096
    v_mfma_f32_16x16x32_bf16 v[128:131], v[16:19], v[60:63], v[128:131]
    ds_read_b64_tr_b16 v[44:45], v8 offset:12352
    v_mfma_f32_16x16x32_bf16 v[132:135], v[20:23], v[60:63], v[132:135]
    ds_read_b64_tr_b16 v[46:47], v8 offset:12864
    buffer_load_dwordx4 v[208:211], v1, s[20:23], s14 offen offset:0 sc1
    v_mfma_f32_16x16x32_bf16 v[136:139], v[24:27], v[60:63], v[136:139]
    v_mfma_f32_16x16x32_bf16 v[140:143], v[28:31], v[60:63], v[140:143]
    ds_read_b128 v[60:63], v3 offset:6144
    v_mfma_f32_16x16x32_bf16 v[96:99], v[16:19], v[248:251], v[96:99]
    v_mfma_f32_16x16x32_bf16 v[100:103], v[20:23], v[248:251], v[100:103]
    buffer_load_dwordx4 v[212:215], v1, s[20:23], s14 offen offset:1024 sc1
    v_mfma_f32_16x16x32_bf16 v[104:107], v[24:27], v[248:251], v[104:107]
    buffer_load_dwordx4 v[216:219], v1, s[20:23], s14 offen offset:2048 sc1
    v_mfma_f32_16x16x32_bf16 v[108:111], v[28:31], v[248:251], v[108:111]
    ds_read_b128 v[248:251], v3 offset:8192
    v_mfma_f32_16x16x32_bf16 v[144:147], v[16:19], v[252:255], v[144:147]
    v_mfma_f32_16x16x32_bf16 v[148:151], v[20:23], v[252:255], v[148:151]
    buffer_load_dwordx4 v[220:223], v1, s[20:23], s14 offen offset:3072 sc1
    s_add_u32 s14, s14, 4096
    v_mfma_f32_16x16x32_bf16 v[152:155], v[24:27], v[252:255], v[152:155]
    v_mfma_f32_16x16x32_bf16 v[156:159], v[28:31], v[252:255], v[156:159]
    ds_read_b128 v[252:255], v3 offset:10240
    s_nop 0
    s_waitcnt lgkmcnt(3)
    v_mfma_f32_16x16x32_bf16 v[64:67], v[32:35], v[48:51], v[64:67]
    v_mfma_f32_16x16x32_bf16 v[68:71], v[36:39], v[48:51], v[68:71]
    buffer_load_dwordx4 v[224:227], v1, s[20:23], s14 offen offset:0 sc1
    v_mfma_f32_16x16x32_bf16 v[72:75], v[40:43], v[48:51], v[72:75]
    v_mfma_f32_16x16x32_bf16 v[76:79], v[44:47], v[48:51], v[76:79]
    v_mfma_f32_16x16x32_bf16 v[112:115], v[32:35], v[52:55], v[112:115]
    v_mfma_f32_16x16x32_bf16 v[116:119], v[36:39], v[52:55], v[116:119]
    buffer_load_dwordx4 v[228:231], v1, s[20:23], s14 offen offset:1024 sc1
    v_mfma_f32_16x16x32_bf16 v[120:123], v[40:43], v[52:55], v[120:123]
    buffer_load_dwordx4 v[232:235], v1, s[20:23], s14 offen offset:2048 sc1
    v_mfma_f32_16x16x32_bf16 v[124:127], v[44:47], v[52:55], v[124:127]
    v_mfma_f32_16x16x32_bf16 v[80:83], v[32:35], v[56:59], v[80:83]
    s_setprio 2
    v_mfma_f32_16x16x32_bf16 v[84:87], v[36:39], v[56:59], v[84:87]
    buffer_load_dwordx4 v[236:239], v1, s[20:23], s14 offen offset:3072 sc1
    s_add_u32 s14, s14, 4096
    v_mfma_f32_16x16x32_bf16 v[88:91], v[40:43], v[56:59], v[88:91]
    v_mfma_f32_16x16x32_bf16 v[92:95], v[44:47], v[56:59], v[92:95]
    s_waitcnt lgkmcnt(2)
    v_mfma_f32_16x16x32_bf16 v[128:131], v[32:35], v[60:63], v[128:131]
    v_mfma_f32_16x16x32_bf16 v[132:135], v[36:39], v[60:63], v[132:135]
    buffer_load_dwordx4 v[240:243], v1, s[20:23], s14 offen offset:0 sc1
    v_mfma_f32_16x16x32_bf16 v[136:139], v[40:43], v[60:63], v[136:139]
    v_mfma_f32_16x16x32_bf16 v[140:143], v[44:47], v[60:63], v[140:143]
    s_waitcnt lgkmcnt(1)
    v_mfma_f32_16x16x32_bf16 v[96:99], v[32:35], v[248:251], v[96:99]
    v_mfma_f32_16x16x32_bf16 v[100:103], v[36:39], v[248:251], v[100:103]
    buffer_load_dwordx4 v[244:247], v1, s[20:23], s14 offen offset:1024 sc1
    v_mfma_f32_16x16x32_bf16 v[104:107], v[40:43], v[248:251], v[104:107]
    v_mfma_f32_16x16x32_bf16 v[108:111], v[44:47], v[248:251], v[108:111]
    s_waitcnt lgkmcnt(0)
    v_mfma_f32_16x16x32_bf16 v[144:147], v[32:35], v[252:255], v[144:147]
    v_mfma_f32_16x16x32_bf16 v[148:151], v[36:39], v[252:255], v[148:151]
    v_mfma_f32_16x16x32_bf16 v[152:155], v[40:43], v[252:255], v[152:155]
    v_mfma_f32_16x16x32_bf16 v[156:159], v[44:47], v[252:255], v[156:159]
k_mj:
    s_load_dword s61, s[58:59], 0
    v_mov_b32 v7, 162652
    v_mov_b32_e64 v5, v11
    v_add_u32 v6, 82048, v11
    s_nop 6
    buffer_load_dwordx4 v[248:251], v1, s[20:23], s14 offen offset:2048 sc1
    v_pk_mul_f32 v[16:17], v[64:65], s[54:55]
    v_pk_mul_f32 v[18:19], v[66:67], s[54:55]
    v_pk_mul_f32 v[20:21], v[68:69], s[54:55]
    v_pk_mul_f32 v[22:23], v[70:71], s[54:55]
    v_exp_f32 v16, v16
    v_exp_f32 v17, v17
    v_exp_f32 v18, v18
    v_exp_f32 v19, v19
    v_exp_f32 v20, v20
    v_exp_f32_e64 v21, v21
    buffer_load_dwordx4 v[252:255], v1, s[20:23], s14 offen offset:3072 sc1
    s_add_u32 s14, s14, 4096
    v_exp_f32 v22, v22
    v_exp_f32 v23, v23
    v_pk_add_f32 v[16:17], v[16:17], 1.0 op_sel_hi:[1,0]
    v_pk_add_f32 v[18:19], v[18:19], 1.0 op_sel_hi:[1,0]
    v_pk_add_f32 v[20:21], v[20:21], 1.0 op_sel_hi:[1,0]
    v_pk_add_f32 v[22:23], v[22:23], 1.0 op_sel_hi:[1,0]
    v_rcp_f32 v16, v16
    v_rcp_f32 v17, v17
    v_rcp_f32 v18, v18
    v_rcp_f32 v19, v19
    buffer_load_dwordx4 v[56:59], v1, s[20:23], s14 offen offset:0 sc1
    v_rcp_f32 v20, v20
    v_rcp_f32 v21, v21
    v_rcp_f32 v22, v22
    v_rcp_f32 v23, v23
    v_pk_mul_f32 v[64:65], v[64:65], v[72:73]
    v_pk_mul_f32 v[66:67], v[66:67], v[74:75]
    v_pk_mul_f32 v[68:69], v[68:69], v[76:77]
    v_pk_mul_f32 v[70:71], v[70:71], v[78:79]
    v_pk_mul_f32 v[64:65], v[64:65], v[16:17]
    v_pk_mul_f32 v[66:67], v[66:67], v[18:19]
    v_pk_mul_f32 v[68:69], v[68:69], v[20:21]
    v_pk_mul_f32 v[70:71], v[70:71], v[22:23]
    v_cvt_pk_bf16_f32 v32, v64, v65
    v_cvt_pk_bf16_f32 v33, v66, v67
    v_cvt_pk_bf16_f32 v34, v68, v69
    v_cvt_pk_bf16_f32 v35, v70, v71
    buffer_store_dwordx4 v[32:35], v10, s[20:23], s48 offen sc1
    buffer_load_dwordx4 v[60:63], v1, s[20:23], s14 offen offset:1024 sc1
    v_pk_mul_f32 v[16:17], v[80:81], s[54:55]
    v_pk_mul_f32 v[18:19], v[82:83], s[54:55]
    v_pk_mul_f32 v[20:21], v[84:85], s[54:55]
    v_pk_mul_f32 v[22:23], v[86:87], s[54:55]
    v_exp_f32 v16, v16
    v_exp_f32 v17, v17
    v_exp_f32 v18, v18
    v_exp_f32 v19, v19
    v_exp_f32 v20, v20
    v_exp_f32 v21, v21
    buffer_load_dwordx4 v[64:67], v1, s[20:23], s14 offen offset:2048 sc1
    v_exp_f32 v22, v22
    v_exp_f32 v23, v23
    v_pk_add_f32 v[16:17], v[16:17], 1.0 op_sel_hi:[1,0]
    v_pk_add_f32 v[18:19], v[18:19], 1.0 op_sel_hi:[1,0]
    v_pk_add_f32 v[20:21], v[20:21], 1.0 op_sel_hi:[1,0]
    v_pk_add_f32 v[22:23], v[22:23], 1.0 op_sel_hi:[1,0]
    v_rcp_f32 v16, v16
    v_rcp_f32 v17, v17
    v_rcp_f32 v18, v18
    v_rcp_f32 v19, v19
    buffer_load_dwordx4 v[68:71], v1, s[20:23], s14 offen offset:3072 sc1
    s_add_u32 s14, s14, 4096
    v_rcp_f32 v20, v20
    v_rcp_f32 v21, v21
    v_rcp_f32 v22, v22
    v_rcp_f32 v23, v23
    v_pk_mul_f32 v[80:81], v[80:81], v[88:89]
    v_pk_mul_f32 v[82:83], v[82:83], v[90:91]
    v_pk_mul_f32 v[84:85], v[84:85], v[92:93]
    v_pk_mul_f32 v[86:87], v[86:87], v[94:95]
    v_pk_mul_f32 v[80:81], v[80:81], v[16:17]
    v_pk_mul_f32 v[82:83], v[82:83], v[18:19]
    v_pk_mul_f32 v[84:85], v[84:85], v[20:21]
    v_pk_mul_f32 v[86:87], v[86:87], v[22:23]
    v_cvt_pk_bf16_f32 v36, v80, v81
    v_cvt_pk_bf16_f32 v37, v82, v83
    v_cvt_pk_bf16_f32 v38, v84, v85
    v_cvt_pk_bf16_f32 v39, v86, v87
    buffer_store_dwordx4 v[36:39], v10, s[20:23], s49 offen sc1
    buffer_load_dwordx4 v[72:75], v1, s[20:23], s14 offen offset:0 sc1
    v_pk_mul_f32 v[16:17], v[96:97], s[54:55]
    v_pk_mul_f32 v[18:19], v[98:99], s[54:55]
    v_pk_mul_f32 v[20:21], v[100:101], s[54:55]
    v_pk_mul_f32 v[22:23], v[102:103], s[54:55]
    v_exp_f32 v16, v16
    v_exp_f32 v17, v17
    v_exp_f32 v18, v18
    v_exp_f32 v19, v19
    v_exp_f32 v20, v20
    v_exp_f32 v21, v21
    v_exp_f32 v22, v22
    v_exp_f32 v23, v23
    v_pk_add_f32 v[16:17], v[16:17], 1.0 op_sel_hi:[1,0]
    v_pk_add_f32 v[18:19], v[18:19], 1.0 op_sel_hi:[1,0]
    v_pk_add_f32 v[20:21], v[20:21], 1.0 op_sel_hi:[1,0]
    v_pk_add_f32 v[22:23], v[22:23], 1.0 op_sel_hi:[1,0]
    buffer_load_dwordx4 v[76:79], v1, s[20:23], s14 offen offset:1024 sc1
    v_rcp_f32 v16, v16
    v_rcp_f32 v17, v17
    v_rcp_f32 v18, v18
    v_rcp_f32 v19, v19
    v_rcp_f32 v20, v20
    v_rcp_f32 v21, v21
    v_rcp_f32 v22, v22
    v_rcp_f32 v23, v23
    v_pk_mul_f32 v[96:97], v[96:97], v[104:105]
    v_pk_mul_f32 v[98:99], v[98:99], v[106:107]
    v_pk_mul_f32 v[100:101], v[100:101], v[108:109]
    v_pk_mul_f32 v[102:103], v[102:103], v[110:111]
    v_pk_mul_f32 v[96:97], v[96:97], v[16:17]
    v_pk_mul_f32 v[98:99], v[98:99], v[18:19]
    v_pk_mul_f32 v[100:101], v[100:101], v[20:21]
    v_pk_mul_f32 v[102:103], v[102:103], v[22:23]
    v_cvt_pk_bf16_f32 v40, v96, v97
    v_cvt_pk_bf16_f32 v41, v98, v99
    v_cvt_pk_bf16_f32 v42, v100, v101
    v_cvt_pk_bf16_f32 v43, v102, v103
    buffer_store_dwordx4 v[40:43], v10, s[20:23], s50 offen sc1
    v_pk_mul_f32 v[16:17], v[112:113], s[54:55]
    v_pk_mul_f32 v[18:19], v[114:115], s[54:55]
    v_pk_mul_f32 v[20:21], v[116:117], s[54:55]
    v_pk_mul_f32 v[22:23], v[118:119], s[54:55]
    v_exp_f32 v16, v16
    v_exp_f32 v17, v17
    v_exp_f32 v18, v18
    v_exp_f32 v19, v19
    v_exp_f32 v20, v20
    v_exp_f32 v21, v21
    v_exp_f32 v22, v22
    v_exp_f32 v23, v23
    v_pk_add_f32 v[16:17], v[16:17], 1.0 op_sel_hi:[1,0]
    v_pk_add_f32 v[18:19], v[18:19], 1.0 op_sel_hi:[1,0]
    v_pk_add_f32 v[20:21], v[20:21], 1.0 op_sel_hi:[1,0]
    v_pk_add_f32 v[22:23], v[22:23], 1.0 op_sel_hi:[1,0]
    v_rcp_f32 v16, v16
    v_rcp_f32 v17, v17
    v_rcp_f32 v18, v18
    v_rcp_f32 v19, v19
    v_rcp_f32 v20, v20
    v_rcp_f32 v21, v21
    v_rcp_f32 v22, v22
    v_rcp_f32 v23, v23
    v_pk_mul_f32 v[112:113], v[112:113], v[120:121]
    v_pk_mul_f32 v[114:115], v[114:115], v[122:123]
    v_pk_mul_f32 v[116:117], v[116:117], v[124:125]
    v_pk_mul_f32 v[118:119], v[118:119], v[126:127]
    v_pk_mul_f32 v[112:113], v[112:113], v[16:17]
    v_pk_mul_f32 v[114:115], v[114:115], v[18:19]
    v_pk_mul_f32 v[116:117], v[116:117], v[20:21]
    v_pk_mul_f32 v[118:119], v[118:119], v[22:23]
    v_cvt_pk_bf16_f32 v44, v112, v113
    v_cvt_pk_bf16_f32 v45, v114, v115
    v_cvt_pk_bf16_f32 v46, v116, v117
    v_cvt_pk_bf16_f32 v47, v118, v119
    buffer_store_dwordx4 v[44:47], v9, s[20:23], s48 offen sc1
    v_pk_mul_f32 v[16:17], v[128:129], s[54:55]
    v_pk_mul_f32 v[18:19], v[130:131], s[54:55]
    v_pk_mul_f32 v[20:21], v[132:133], s[54:55]
    v_pk_mul_f32 v[22:23], v[134:135], s[54:55]
    v_exp_f32 v16, v16
    v_exp_f32 v17, v17
    v_exp_f32 v18, v18
    v_exp_f32 v19, v19
    v_exp_f32 v20, v20
    v_exp_f32 v21, v21
    v_exp_f32 v22, v22
    v_exp_f32 v23, v23
    v_pk_add_f32 v[16:17], v[16:17], 1.0 op_sel_hi:[1,0]
    v_pk_add_f32 v[18:19], v[18:19], 1.0 op_sel_hi:[1,0]
    v_pk_add_f32 v[20:21], v[20:21], 1.0 op_sel_hi:[1,0]
    v_pk_add_f32 v[22:23], v[22:23], 1.0 op_sel_hi:[1,0]
    v_rcp_f32 v16, v16
    v_rcp_f32 v17, v17
    v_rcp_f32 v18, v18
    v_rcp_f32 v19, v19
    v_rcp_f32 v20, v20
    v_rcp_f32 v21, v21
    v_rcp_f32 v22, v22
    v_rcp_f32 v23, v23
    v_pk_mul_f32 v[128:129], v[128:129], v[136:137]
    v_pk_mul_f32 v[130:131], v[130:131], v[138:139]
    v_pk_mul_f32 v[132:133], v[132:133], v[140:141]
    v_pk_mul_f32 v[134:135], v[134:135], v[142:143]
    v_pk_mul_f32 v[128:129], v[128:129], v[16:17]
    v_pk_mul_f32 v[130:131], v[130:131], v[18:19]
    v_pk_mul_f32 v[132:133], v[132:133], v[20:21]
    v_pk_mul_f32 v[134:135], v[134:135], v[22:23]
    v_cvt_pk_bf16_f32 v32, v128, v129
    v_cvt_pk_bf16_f32 v33, v130, v131
    v_cvt_pk_bf16_f32 v34, v132, v133
    v_cvt_pk_bf16_f32 v35, v134, v135
    buffer_store_dwordx4 v[32:35], v9, s[20:23], s49 offen sc1
    v_pk_mul_f32 v[16:17], v[144:145], s[54:55]
    v_pk_mul_f32 v[18:19], v[146:147], s[54:55]
    v_pk_mul_f32 v[20:21], v[148:149], s[54:55]
    v_pk_mul_f32 v[22:23], v[150:151], s[54:55]
    v_exp_f32 v16, v16
    v_exp_f32 v17, v17
    v_exp_f32 v18, v18
    v_exp_f32 v19, v19
    v_exp_f32 v20, v20
    v_exp_f32 v21, v21
    v_exp_f32 v22, v22
    v_exp_f32 v23, v23
    v_pk_add_f32 v[16:17], v[16:17], 1.0 op_sel_hi:[1,0]
    v_pk_add_f32 v[18:19], v[18:19], 1.0 op_sel_hi:[1,0]
    v_pk_add_f32 v[20:21], v[20:21], 1.0 op_sel_hi:[1,0]
    v_pk_add_f32 v[22:23], v[22:23], 1.0 op_sel_hi:[1,0]
    v_rcp_f32 v16, v16
    v_rcp_f32 v17, v17
    v_rcp_f32 v18, v18
    v_rcp_f32 v19, v19
    v_rcp_f32 v20, v20
    v_rcp_f32 v21, v21
    v_rcp_f32 v22, v22
    v_rcp_f32 v23, v23
    v_pk_mul_f32 v[144:145], v[144:145], v[152:153]
    v_pk_mul_f32 v[146:147], v[146:147], v[154:155]
    v_pk_mul_f32 v[148:149], v[148:149], v[156:157]
    v_pk_mul_f32 v[150:151], v[150:151], v[158:159]
    v_pk_mul_f32 v[144:145], v[144:145], v[16:17]
    v_pk_mul_f32 v[146:147], v[146:147], v[18:19]
    v_pk_mul_f32 v[148:149], v[148:149], v[20:21]
    v_pk_mul_f32 v[150:151], v[150:151], v[22:23]
    v_cvt_pk_bf16_f32 v36, v144, v145
    v_cvt_pk_bf16_f32 v37, v146, v147
    v_cvt_pk_bf16_f32 v38, v148, v149
    v_cvt_pk_bf16_f32 v39, v150, v151
    buffer_store_dwordx4 v[36:39], v9, s[20:23], s50 offen sc1
    s_barrier
    s_setprio 0
    s_mov_b32 s62, 0
    s_waitcnt lgkmcnt(0)
tg_17:
    s_cmp_lg_u32 s61, 0
    s_cbranch_scc1 tg_18
    v_mov_b32_e64 v14, 0
    global_load_dword v14, v14, s[58:59] sc1
    s_addk_i32 s62, 1
    s_waitcnt vmcnt(0)
    v_readfirstlane_b32 s61, v14
    s_sleep 1
    s_cmpk_lt_u32 s62, 0x3000
    s_cbranch_scc1 tg_17
tg_18:
    v_mov_b32_e64 v14, s61
    v_lshl_add_u32 v15, v0, 2, s46
    v_writelane_b32 v15, s47, 2
    s_mov_b64 exec, 7
    s_waitcnt vmcnt(0)
    buffer_store_dword v14, v15, s[20:23], s51 offen sc1
    s_mov_b64 exec, -1
    s_mul_i32 s10, s3, 10240
    s_add_u32 s14, s14, s18
    s_add_u32 m0, s10, 41024
    s_add_u32 s11, s14, 0
    s_nop 0
    buffer_load_dwordx4 v1, s[20:23], s11 offen offset:0 sc1 lds
    buffer_load_dwordx4 v1, s[20:23], s11 offen offset:1024 sc1 lds
    buffer_load_dwordx4 v1, s[20:23], s11 offen offset:2048 sc1 lds
    buffer_load_dwordx4 v1, s[20:23], s11 offen offset:3072 sc1 lds
    s_add_u32 m0, s10, 45120
    s_add_u32 s11, s14, 4096
    buffer_load_dwordx4 v1, s[20:23], s11 offen offset:0 sc1 lds
    buffer_load_dwordx4 v1, s[20:23], s11 offen offset:1024 sc1 lds
    buffer_load_dwordx4 v1, s[20:23], s11 offen offset:2048 sc1 lds
    buffer_load_dwordx4 v1, s[20:23], s11 offen offset:3072 sc1 lds
    s_add_u32 m0, s10, 49216
    s_add_u32 s11, s14, 8192
    buffer_load_dwordx4 v1, s[20:23], s11 offen offset:0 sc1 lds
    buffer_load_dwordx4 v1, s[20:23], s11 offen offset:1024 sc1 lds
    s_add_u32 m0, s10, 82048
    s_add_u32 s11, s14, 10240
    buffer_load_dwordx4 v1, s[20:23], s11 offen offset:0 sc1 lds
    buffer_load_dwordx4 v1, s[20:23], s11 offen offset:1024 sc1 lds
    buffer_load_dwordx4 v1, s[20:23], s11 offen offset:2048 sc1 lds
    buffer_load_dwordx4 v1, s[20:23], s11 offen offset:3072 sc1 lds
    s_add_u32 m0, s10, 86144
    s_add_u32 s11, s14, 14336
    buffer_load_dwordx4 v1, s[20:23], s11 offen offset:0 sc1 lds
    buffer_load_dwordx4 v1, s[20:23], s11 offen offset:1024 sc1 lds
    buffer_load_dwordx4 v1, s[20:23], s11 offen offset:2048 sc1 lds
    buffer_load_dwordx4 v1, s[20:23], s11 offen offset:3072 sc1 lds
    s_add_u32 m0, s10, 90240
    s_add_u32 s11, s14, 18432
    buffer_load_dwordx4 v1, s[20:23], s11 offen offset:0 sc1 lds
    buffer_load_dwordx4 v1, s[20:23], s11 offen offset:1024 sc1 lds
    s_add_u32 m0, s10, 0
    s_nop 0
    s_add_u32 s11, s14, 20480
    buffer_load_dwordx4 v1, s[20:23], s11 offen offset:0 sc1 lds
    buffer_load_dwordx4 v1, s[20:23], s11 offen offset:1024 sc1 lds
    s_load_dwordx16 s[32:47], s[20:21], s52 glc
    s_load_dwordx8 s[24:31], s[20:21], s52 offset:64 glc
    buffer_load_dwordx4 v1, s[20:23], s11 offen offset:2048 sc1 lds
    buffer_load_dwordx4 v1, s[20:23], s11 offen offset:3072 sc1 lds
    s_add_u32 m0, s10, 4096
    s_add_u32 s11, s14, 24576
    buffer_load_dwordx4 v1, s[20:23], s11 offen offset:0 sc1 lds
    buffer_load_dwordx4 v1, s[20:23], s11 offen offset:1024 sc1 lds
    buffer_load_dwordx4 v1, s[20:23], s11 offen offset:2048 sc1 lds
    buffer_load_dwordx4 v1, s[20:23], s11 offen offset:3072 sc1 lds
    s_add_u32 m0, s10, 8192
    s_add_u32 s11, s14, 28672
    buffer_load_dwordx4 v1, s[20:23], s11 offen offset:0 sc1 lds
    buffer_load_dwordx4 v1, s[20:23], s11 offen offset:1024 sc1 lds
    v_and_b32 v4, 15, v0
    v_lshrrev_b32 v3, 4, v0
    v_mul_u32_u24 v2, 176, v4
    v_lshl_add_u32 v2, v3, 3, v2
    s_mul_i32 s10, s3, 10240
    v_add_u32 v2, s10, v2
    s_mov_b32 s62, 0
    s_branch sp_21
sp_19:
    s_load_dwordx16 s[32:47], s[20:21], s52 glc
    s_load_dwordx8 s[24:31], s[20:21], s52 offset:64 glc
sp_21:
    s_addk_i32 s62, 1
    s_waitcnt lgkmcnt(0)
    s_and_b64 s[10:11], s[24:25], s[26:27]
    s_or_b64 s[12:13], s[24:25], s[26:27]
    s_and_b64 s[10:11], s[10:11], s[28:29]
    s_or_b64 s[12:13], s[12:13], s[28:29]
    s_and_b64 s[10:11], s[10:11], s[30:31]
    s_or_b64 s[12:13], s[12:13], s[30:31]
    s_and_b64 s[10:11], s[10:11], s[32:33]
    s_or_b64 s[12:13], s[12:13], s[32:33]
    s_and_b64 s[10:11], s[10:11], s[34:35]
    s_or_b64 s[12:13], s[12:13], s[34:35]
    s_and_b64 s[10:11], s[10:11], s[36:37]
    s_or_b64 s[12:13], s[12:13], s[36:37]
    s_and_b64 s[10:11], s[10:11], s[38:39]
    s_or_b64 s[12:13], s[12:13], s[38:39]
    s_and_b64 s[10:11], s[10:11], s[40:41]
    s_or_b64 s[12:13], s[12:13], s[40:41]
    s_and_b64 s[10:11], s[10:11], s[42:43]
    s_or_b64 s[12:13], s[12:13], s[42:43]
    s_and_b64 s[10:11], s[10:11], s[44:45]
    s_or_b64 s[12:13], s[12:13], s[44:45]
    s_and_b64 s[10:11], s[10:11], s[46:47]
    s_or_b64 s[12:13], s[12:13], s[46:47]
    s_and_b32 s10, s10, s11
    s_or_b32 s12, s12, s13
    s_xor_b32 s10, s10, s61
    s_xor_b32 s12, s12, s61
    s_or_b32 s10, s10, s12
    s_cbranch_scc0 sp_20
    s_sleep 1
    s_cmpk_lt_u32 s62, 0x3000
    s_cbranch_scc1 sp_19
sp_20:
    buffer_load_dwordx4 v[8:11], v1, s[20:23], s53 offen offset:0 sc1
    buffer_load_dwordx4 v[12:15], v1, s[20:23], s53 offen offset:1024 sc1
    buffer_load_dwordx4 v[16:19], v1, s[20:23], s53 offen offset:2048 sc1
    buffer_load_dwordx4 v[20:23], v1, s[20:23], s53 offen offset:3072 sc1
    s_add_u32 s53, s53, 4096
    buffer_load_dwordx4 v[24:27], v1, s[20:23], s53 offen offset:0 sc1
    buffer_load_dwordx4 v[28:31], v1, s[20:23], s53 offen offset:1024 sc1
    buffer_load_dwordx4 v[32:35], v1, s[20:23], s53 offen offset:2048 sc1
    buffer_load_dwordx4 v[36:39], v1, s[20:23], s53 offen offset:3072 sc1
    s_add_u32 s53, s53, 4096
    buffer_load_dwordx4 v[40:43], v1, s[20:23], s53 offen offset:0 sc1
    buffer_load_dwordx4 v[44:47], v1, s[20:23], s53 offen offset:1024 sc1
    buffer_load_dwordx4 v[48:51], v1, s[20:23], s53 offen offset:2048 sc1
    buffer_load_dwordx4 v[52:55], v1, s[20:23], s53 offen offset:3072 sc1
    s_add_u32 s53, s53, 4096
    s_waitcnt vmcnt(11) lgkmcnt(0)
    v_mfma_f32_16x16x32_bf16 v[80:83], v[160:163], v[8:11], 0
    v_mfma_f32_16x16x32_bf16 v[96:99], v[164:167], v[8:11], 0
    v_mfma_f32_16x16x32_bf16 v[112:115], v[168:171], v[8:11], 0
    v_mfma_f32_16x16x32_bf16 v[128:131], v[172:175], v[8:11], 0
    v_mfma_f32_16x16x32_bf16 v[144:147], v[176:179], v[8:11], 0
    buffer_load_dwordx4 v[8:11], v1, s[20:23], s53 offen offset:0 sc1
    s_waitcnt vmcnt(11)
    v_mfma_f32_16x16x32_bf16 v[84:87], v[160:163], v[12:15], 0
    v_mfma_f32_16x16x32_bf16 v[100:103], v[164:167], v[12:15], 0
    v_mfma_f32_16x16x32_bf16 v[116:119], v[168:171], v[12:15], 0
    v_mfma_f32_16x16x32_bf16 v[132:135], v[172:175], v[12:15], 0
    v_mfma_f32_16x16x32_bf16 v[148:151], v[176:179], v[12:15], 0
    buffer_load_dwordx4 v[12:15], v1, s[20:23], s53 offen offset:1024 sc1
    s_waitcnt vmcnt(11)
    v_mfma_f32_16x16x32_bf16 v[88:91], v[160:163], v[16:19], 0
    v_mfma_f32_16x16x32_bf16 v[104:107], v[164:167], v[16:19], 0
    v_mfma_f32_16x16x32_bf16 v[120:123], v[168:171], v[16:19], 0
    v_mfma_f32_16x16x32_bf16 v[136:139], v[172:175], v[16:19], 0
    v_mfma_f32_16x16x32_bf16 v[152:155], v[176:179], v[16:19], 0
    buffer_load_dwordx4 v[16:19], v1, s[20:23], s53 offen offset:2048 sc1
    s_waitcnt vmcnt(11)
    v_mfma_f32_16x16x32_bf16 v[92:95], v[160:163], v[20:23], 0
    v_mfma_f32_16x16x32_bf16 v[108:111], v[164:167], v[20:23], 0
    v_mfma_f32_16x16x32_bf16 v[124:127], v[168:171], v[20:23], 0
    v_mfma_f32_16x16x32_bf16 v[140:143], v[172:175], v[20:23], 0
    v_mfma_f32_16x16x32_bf16 v[156:159], v[176:179], v[20:23], 0
    buffer_load_dwordx4 v[20:23], v1, s[20:23], s53 offen offset:3072 sc1
    s_add_u32 s53, s53, 4096
    s_waitcnt vmcnt(11)
    v_mfma_f32_16x16x32_bf16 v[80:83], v[180:183], v[24:27], v[80:83]
    v_mfma_f32_16x16x32_bf16 v[96:99], v[184:187], v[24:27], v[96:99]
    v_mfma_f32_16x16x32_bf16 v[112:115], v[188:191], v[24:27], v[112:115]
    v_mfma_f32_16x16x32_bf16 v[128:131], v[192:195], v[24:27], v[128:131]
    v_mfma_f32_16x16x32_bf16 v[144:147], v[196:199], v[24:27], v[144:147]
    buffer_load_dwordx4 v[24:27], v1, s[20:23], s53 offen offset:0 sc1
    s_waitcnt vmcnt(11)
    v_mfma_f32_16x16x32_bf16 v[84:87], v[180:183], v[28:31], v[84:87]
    v_mfma_f32_16x16x32_bf16 v[100:103], v[184:187], v[28:31], v[100:103]
    v_mfma_f32_16x16x32_bf16 v[116:119], v[188:191], v[28:31], v[116:119]
    v_mfma_f32_16x16x32_bf16 v[132:135], v[192:195], v[28:31], v[132:135]
    v_mfma_f32_16x16x32_bf16 v[148:151], v[196:199], v[28:31], v[148:151]
    buffer_load_dwordx4 v[28:31], v1, s[20:23], s53 offen offset:1024 sc1
    s_waitcnt vmcnt(11)
    v_mfma_f32_16x16x32_bf16 v[88:91], v[180:183], v[32:35], v[88:91]
    v_mfma_f32_16x16x32_bf16 v[104:107], v[184:187], v[32:35], v[104:107]
    v_mfma_f32_16x16x32_bf16 v[120:123], v[188:191], v[32:35], v[120:123]
    v_mfma_f32_16x16x32_bf16 v[136:139], v[192:195], v[32:35], v[136:139]
    v_mfma_f32_16x16x32_bf16 v[152:155], v[196:199], v[32:35], v[152:155]
    buffer_load_dwordx4 v[32:35], v1, s[20:23], s53 offen offset:2048 sc1
    s_waitcnt vmcnt(11)
    v_mfma_f32_16x16x32_bf16 v[92:95], v[180:183], v[36:39], v[92:95]
    v_mfma_f32_16x16x32_bf16 v[108:111], v[184:187], v[36:39], v[108:111]
    v_mfma_f32_16x16x32_bf16 v[124:127], v[188:191], v[36:39], v[124:127]
    v_mfma_f32_16x16x32_bf16 v[140:143], v[192:195], v[36:39], v[140:143]
    v_mfma_f32_16x16x32_bf16 v[156:159], v[196:199], v[36:39], v[156:159]
    buffer_load_dwordx4 v[36:39], v1, s[20:23], s53 offen offset:3072 sc1
    s_add_u32 s53, s53, 4096
    s_waitcnt vmcnt(11)
    v_mfma_f32_16x16x32_bf16 v[80:83], v[200:203], v[40:43], v[80:83]
    v_mfma_f32_16x16x32_bf16 v[96:99], v[204:207], v[40:43], v[96:99]
    v_mfma_f32_16x16x32_bf16 v[112:115], v[208:211], v[40:43], v[112:115]
    v_mfma_f32_16x16x32_bf16 v[128:131], v[212:215], v[40:43], v[128:131]
    v_mfma_f32_16x16x32_bf16 v[144:147], v[216:219], v[40:43], v[144:147]
    buffer_load_dwordx4 v[40:43], v1, s[20:23], s53 offen offset:0 sc1
    s_waitcnt vmcnt(11)
    v_mfma_f32_16x16x32_bf16 v[84:87], v[200:203], v[44:47], v[84:87]
    v_mfma_f32_16x16x32_bf16 v[100:103], v[204:207], v[44:47], v[100:103]
    v_mfma_f32_16x16x32_bf16 v[116:119], v[208:211], v[44:47], v[116:119]
    v_mfma_f32_16x16x32_bf16 v[132:135], v[212:215], v[44:47], v[132:135]
    v_mfma_f32_16x16x32_bf16 v[148:151], v[216:219], v[44:47], v[148:151]
    buffer_load_dwordx4 v[44:47], v1, s[20:23], s53 offen offset:1024 sc1
    s_waitcnt vmcnt(11)
    v_mfma_f32_16x16x32_bf16 v[88:91], v[200:203], v[48:51], v[88:91]
    v_mfma_f32_16x16x32_bf16 v[104:107], v[204:207], v[48:51], v[104:107]
    v_mfma_f32_16x16x32_bf16 v[120:123], v[208:211], v[48:51], v[120:123]
    v_mfma_f32_16x16x32_bf16 v[136:139], v[212:215], v[48:51], v[136:139]
    v_mfma_f32_16x16x32_bf16 v[152:155], v[216:219], v[48:51], v[152:155]
    buffer_load_dwordx4 v[48:51], v1, s[20:23], s53 offen offset:2048 sc1
    s_waitcnt vmcnt(11)
    v_mfma_f32_16x16x32_bf16 v[92:95], v[200:203], v[52:55], v[92:95]
    v_mfma_f32_16x16x32_bf16 v[108:111], v[204:207], v[52:55], v[108:111]
    v_mfma_f32_16x16x32_bf16 v[124:127], v[208:211], v[52:55], v[124:127]
    v_mfma_f32_16x16x32_bf16 v[140:143], v[212:215], v[52:55], v[140:143]
    v_mfma_f32_16x16x32_bf16 v[156:159], v[216:219], v[52:55], v[156:159]
    buffer_load_dwordx4 v[52:55], v1, s[20:23], s53 offen offset:3072 sc1
    s_add_u32 s53, s53, s15
    s_waitcnt vmcnt(11)
    v_mfma_f32_16x16x32_bf16 v[80:83], v[220:223], v[8:11], v[80:83]
    v_mfma_f32_16x16x32_bf16 v[96:99], v[224:227], v[8:11], v[96:99]
    v_mfma_f32_16x16x32_bf16 v[112:115], v[228:231], v[8:11], v[112:115]
    v_mfma_f32_16x16x32_bf16 v[128:131], v[232:235], v[8:11], v[128:131]
    v_mfma_f32_16x16x32_bf16 v[144:147], v[236:239], v[8:11], v[144:147]
    buffer_load_dwordx4 v[8:11], v1, s[20:23], s53 offen offset:0 sc1
    s_waitcnt vmcnt(11)
    v_mfma_f32_16x16x32_bf16 v[84:87], v[220:223], v[12:15], v[84:87]
    v_mfma_f32_16x16x32_bf16 v[100:103], v[224:227], v[12:15], v[100:103]
    v_mfma_f32_16x16x32_bf16 v[116:119], v[228:231], v[12:15], v[116:119]
    v_mfma_f32_16x16x32_bf16 v[132:135], v[232:235], v[12:15], v[132:135]
    v_mfma_f32_16x16x32_bf16 v[148:151], v[236:239], v[12:15], v[148:151]
    buffer_load_dwordx4 v[12:15], v1, s[20:23], s53 offen offset:1024 sc1
    s_waitcnt vmcnt(11)
    v_mfma_f32_16x16x32_bf16 v[88:91], v[220:223], v[16:19], v[88:91]
    v_mfma_f32_16x16x32_bf16 v[104:107], v[224:227], v[16:19], v[104:107]
    v_mfma_f32_16x16x32_bf16 v[120:123], v[228:231], v[16:19], v[120:123]
    v_mfma_f32_16x16x32_bf16 v[136:139], v[232:235], v[16:19], v[136:139]
    v_mfma_f32_16x16x32_bf16 v[152:155], v[236:239], v[16:19], v[152:155]
    buffer_load_dwordx4 v[16:19], v1, s[20:23], s53 offen offset:2048 sc1
    s_waitcnt vmcnt(11)
    v_mfma_f32_16x16x32_bf16 v[92:95], v[220:223], v[20:23], v[92:95]
    v_mfma_f32_16x16x32_bf16 v[108:111], v[224:227], v[20:23], v[108:111]
    v_mfma_f32_16x16x32_bf16 v[124:127], v[228:231], v[20:23], v[124:127]
    v_mfma_f32_16x16x32_bf16 v[140:143], v[232:235], v[20:23], v[140:143]
    v_mfma_f32_16x16x32_bf16 v[156:159], v[236:239], v[20:23], v[156:159]
    buffer_load_dwordx4 v[20:23], v1, s[20:23], s53 offen offset:3072 sc1
    s_add_u32 s53, s53, 4096
    s_waitcnt vmcnt(11)
    v_mfma_f32_16x16x32_bf16 v[80:83], v[240:243], v[24:27], v[80:83]
    v_mfma_f32_16x16x32_bf16 v[96:99], v[244:247], v[24:27], v[96:99]
    v_mfma_f32_16x16x32_bf16 v[112:115], v[248:251], v[24:27], v[112:115]
    v_mfma_f32_16x16x32_bf16 v[128:131], v[252:255], v[24:27], v[128:131]
    v_mfma_f32_16x16x32_bf16 v[144:147], v[56:59], v[24:27], v[144:147]
    buffer_load_dwordx4 v[24:27], v1, s[20:23], s53 offen offset:0 sc1
    s_waitcnt vmcnt(11)
    v_mfma_f32_16x16x32_bf16 v[84:87], v[240:243], v[28:31], v[84:87]
    v_mfma_f32_16x16x32_bf16 v[100:103], v[244:247], v[28:31], v[100:103]
    v_mfma_f32_16x16x32_bf16 v[116:119], v[248:251], v[28:31], v[116:119]
    v_mfma_f32_16x16x32_bf16 v[132:135], v[252:255], v[28:31], v[132:135]
    v_mfma_f32_16x16x32_bf16 v[148:151], v[56:59], v[28:31], v[148:151]
    buffer_load_dwordx4 v[28:31], v1, s[20:23], s53 offen offset:1024 sc1
    s_waitcnt vmcnt(11)
    v_mfma_f32_16x16x32_bf16 v[88:91], v[240:243], v[32:35], v[88:91]
    ds_read_b128 v[160:163], v5 offset:41024
    v_mfma_f32_16x16x32_bf16 v[104:107], v[244:247], v[32:35], v[104:107]
    ds_read_b128 v[164:167], v5 offset:42048
    v_mfma_f32_16x16x32_bf16 v[120:123], v[248:251], v[32:35], v[120:123]
    ds_read_b128 v[168:171], v5 offset:43072
    v_mfma_f32_16x16x32_bf16 v[136:139], v[252:255], v[32:35], v[136:139]
    ds_read_b128 v[172:175], v5 offset:44096
    v_mfma_f32_16x16x32_bf16 v[152:155], v[56:59], v[32:35], v[152:155]
    ds_read_b128 v[176:179], v5 offset:45120
    buffer_load_dwordx4 v[32:35], v1, s[20:23], s53 offen offset:2048 sc1
    s_waitcnt vmcnt(11)
    v_mfma_f32_16x16x32_bf16 v[92:95], v[240:243], v[36:39], v[92:95]
    v_mfma_f32_16x16x32_bf16 v[108:111], v[244:247], v[36:39], v[108:111]
    v_mfma_f32_16x16x32_bf16 v[124:127], v[248:251], v[36:39], v[124:127]
    v_mfma_f32_16x16x32_bf16 v[140:143], v[252:255], v[36:39], v[140:143]
    v_mfma_f32_16x16x32_bf16 v[156:159], v[56:59], v[36:39], v[156:159]
    buffer_load_dwordx4 v[36:39], v1, s[20:23], s53 offen offset:3072 sc1
    s_add_u32 s53, s53, 4096
    s_waitcnt vmcnt(11)
    v_mfma_f32_16x16x32_bf16 v[80:83], v[60:63], v[40:43], v[80:83]
    v_mfma_f32_16x16x32_bf16 v[96:99], v[64:67], v[40:43], v[96:99]
    v_mfma_f32_16x16x32_bf16 v[112:115], v[68:71], v[40:43], v[112:115]
    v_mfma_f32_16x16x32_bf16 v[128:131], v[72:75], v[40:43], v[128:131]
    v_mfma_f32_16x16x32_bf16 v[144:147], v[76:79], v[40:43], v[144:147]
    buffer_load_dwordx4 v[40:43], v1, s[20:23], s53 offen offset:0 sc1
    s_waitcnt vmcnt(11)
    v_mfma_f32_16x16x32_bf16 v[84:87], v[60:63], v[44:47], v[84:87]
    v_mfma_f32_16x16x32_bf16 v[100:103], v[64:67], v[44:47], v[100:103]
    v_mfma_f32_16x16x32_bf16 v[116:119], v[68:71], v[44:47], v[116:119]
    v_mfma_f32_16x16x32_bf16 v[132:135], v[72:75], v[44:47], v[132:135]
    v_mfma_f32_16x16x32_bf16 v[148:151], v[76:79], v[44:47], v[148:151]
    buffer_load_dwordx4 v[44:47], v1, s[20:23], s53 offen offset:1024 sc1
    s_waitcnt vmcnt(11)
    v_mfma_f32_16x16x32_bf16 v[88:91], v[60:63], v[48:51], v[88:91]
    ds_read_b128 v[180:183], v5 offset:46144
    v_mfma_f32_16x16x32_bf16 v[104:107], v[64:67], v[48:51], v[104:107]
    ds_read_b128 v[184:187], v5 offset:47168
    v_mfma_f32_16x16x32_bf16 v[120:123], v[68:71], v[48:51], v[120:123]
    ds_read_b128 v[188:191], v5 offset:48192
    v_mfma_f32_16x16x32_bf16 v[136:139], v[72:75], v[48:51], v[136:139]
    ds_read_b128 v[192:195], v5 offset:49216
    v_mfma_f32_16x16x32_bf16 v[152:155], v[76:79], v[48:51], v[152:155]
    ds_read_b128 v[196:199], v5 offset:50240
    buffer_load_dwordx4 v[48:51], v1, s[20:23], s53 offen offset:2048 sc1
    s_waitcnt vmcnt(11)
    v_mfma_f32_16x16x32_bf16 v[92:95], v[60:63], v[52:55], v[92:95]
    v_mfma_f32_16x16x32_bf16 v[108:111], v[64:67], v[52:55], v[108:111]
    v_mfma_f32_16x16x32_bf16 v[124:127], v[68:71], v[52:55], v[124:127]
    v_mfma_f32_16x16x32_bf16 v[140:143], v[72:75], v[52:55], v[140:143]
    v_mfma_f32_16x16x32_bf16 v[156:159], v[76:79], v[52:55], v[156:159]
    buffer_load_dwordx4 v[52:55], v1, s[20:23], s53 offen offset:3072 sc1
    s_add_u32 s53, s53, 4096
    s_waitcnt vmcnt(11) lgkmcnt(5)
    v_mfma_f32_16x16x32_bf16 v[80:83], v[160:163], v[8:11], v[80:83]
    v_mfma_f32_16x16x32_bf16 v[96:99], v[164:167], v[8:11], v[96:99]
    v_mfma_f32_16x16x32_bf16 v[112:115], v[168:171], v[8:11], v[112:115]
    v_mfma_f32_16x16x32_bf16 v[128:131], v[172:175], v[8:11], v[128:131]
    v_mfma_f32_16x16x32_bf16 v[144:147], v[176:179], v[8:11], v[144:147]
    buffer_load_dwordx4 v[8:11], v1, s[20:23], s53 offen offset:0 sc1
    s_waitcnt vmcnt(11)
    v_mfma_f32_16x16x32_bf16 v[84:87], v[160:163], v[12:15], v[84:87]
    v_mfma_f32_16x16x32_bf16 v[100:103], v[164:167], v[12:15], v[100:103]
    v_mfma_f32_16x16x32_bf16 v[116:119], v[168:171], v[12:15], v[116:119]
    v_mfma_f32_16x16x32_bf16 v[132:135], v[172:175], v[12:15], v[132:135]
    v_mfma_f32_16x16x32_bf16 v[148:151], v[176:179], v[12:15], v[148:151]
    buffer_load_dwordx4 v[12:15], v1, s[20:23], s53 offen offset:1024 sc1
    s_waitcnt vmcnt(11)
    v_mfma_f32_16x16x32_bf16 v[88:91], v[160:163], v[16:19], v[88:91]
    ds_read_b128 v[200:203], v6 offset:0
    v_mfma_f32_16x16x32_bf16 v[104:107], v[164:167], v[16:19], v[104:107]
    ds_read_b128 v[204:207], v6 offset:1024
    v_mfma_f32_16x16x32_bf16 v[120:123], v[168:171], v[16:19], v[120:123]
    ds_read_b128 v[208:211], v6 offset:2048
    v_mfma_f32_16x16x32_bf16 v[136:139], v[172:175], v[16:19], v[136:139]
    ds_read_b128 v[212:215], v6 offset:3072
    v_mfma_f32_16x16x32_bf16 v[152:155], v[176:179], v[16:19], v[152:155]
    ds_read_b128 v[216:219], v6 offset:4096
    buffer_load_dwordx4 v[16:19], v1, s[20:23], s53 offen offset:2048 sc1
    s_waitcnt vmcnt(11)
    v_mfma_f32_16x16x32_bf16 v[92:95], v[160:163], v[20:23], v[92:95]
    v_mfma_f32_16x16x32_bf16 v[108:111], v[164:167], v[20:23], v[108:111]
    v_mfma_f32_16x16x32_bf16 v[124:127], v[168:171], v[20:23], v[124:127]
    v_mfma_f32_16x16x32_bf16 v[140:143], v[172:175], v[20:23], v[140:143]
    v_mfma_f32_16x16x32_bf16 v[156:159], v[176:179], v[20:23], v[156:159]
    buffer_load_dwordx4 v[20:23], v1, s[20:23], s53 offen offset:3072 sc1
    s_add_u32 s53, s53, 4096
    s_waitcnt vmcnt(11) lgkmcnt(5)
    v_mfma_f32_16x16x32_bf16 v[80:83], v[180:183], v[24:27], v[80:83]
    v_mfma_f32_16x16x32_bf16 v[96:99], v[184:187], v[24:27], v[96:99]
    v_mfma_f32_16x16x32_bf16 v[112:115], v[188:191], v[24:27], v[112:115]
    v_mfma_f32_16x16x32_bf16 v[128:131], v[192:195], v[24:27], v[128:131]
    v_mfma_f32_16x16x32_bf16 v[144:147], v[196:199], v[24:27], v[144:147]
    buffer_load_dwordx4 v[24:27], v1, s[20:23], s53 offen offset:0 sc1
    s_waitcnt vmcnt(11)
    v_mfma_f32_16x16x32_bf16 v[84:87], v[180:183], v[28:31], v[84:87]
    v_mfma_f32_16x16x32_bf16 v[100:103], v[184:187], v[28:31], v[100:103]
    v_mfma_f32_16x16x32_bf16 v[116:119], v[188:191], v[28:31], v[116:119]
    v_mfma_f32_16x16x32_bf16 v[132:135], v[192:195], v[28:31], v[132:135]
    v_mfma_f32_16x16x32_bf16 v[148:151], v[196:199], v[28:31], v[148:151]
    buffer_load_dwordx4 v[28:31], v1, s[20:23], s53 offen offset:1024 sc1
    s_waitcnt vmcnt(11)
    v_mfma_f32_16x16x32_bf16 v[88:91], v[180:183], v[32:35], v[88:91]
    ds_read_b128 v[220:223], v6 offset:5120
    v_mfma_f32_16x16x32_bf16 v[104:107], v[184:187], v[32:35], v[104:107]
    ds_read_b128 v[224:227], v6 offset:6144
    v_mfma_f32_16x16x32_bf16 v[120:123], v[188:191], v[32:35], v[120:123]
    ds_read_b128 v[228:231], v6 offset:7168
    v_mfma_f32_16x16x32_bf16 v[136:139], v[192:195], v[32:35], v[136:139]
    ds_read_b128 v[232:235], v6 offset:8192
    v_mfma_f32_16x16x32_bf16 v[152:155], v[196:199], v[32:35], v[152:155]
    ds_read_b128 v[236:239], v6 offset:9216
    buffer_load_dwordx4 v[32:35], v1, s[20:23], s53 offen offset:2048 sc1
    s_waitcnt vmcnt(11)
    v_mfma_f32_16x16x32_bf16 v[92:95], v[180:183], v[36:39], v[92:95]
    v_mfma_f32_16x16x32_bf16 v[108:111], v[184:187], v[36:39], v[108:111]
    v_mfma_f32_16x16x32_bf16 v[124:127], v[188:191], v[36:39], v[124:127]
    v_mfma_f32_16x16x32_bf16 v[140:143], v[192:195], v[36:39], v[140:143]
    v_mfma_f32_16x16x32_bf16 v[156:159], v[196:199], v[36:39], v[156:159]
    buffer_load_dwordx4 v[36:39], v1, s[20:23], s53 offen offset:3072 sc1
    s_add_u32 s53, s53, 4096
    s_waitcnt vmcnt(11) lgkmcnt(5)
    v_mfma_f32_16x16x32_bf16 v[80:83], v[200:203], v[40:43], v[80:83]
    v_mfma_f32_16x16x32_bf16 v[96:99], v[204:207], v[40:43], v[96:99]
    v_mfma_f32_16x16x32_bf16 v[112:115], v[208:211], v[40:43], v[112:115]
    v_mfma_f32_16x16x32_bf16 v[128:131], v[212:215], v[40:43], v[128:131]
    v_mfma_f32_16x16x32_bf16 v[144:147], v[216:219], v[40:43], v[144:147]
    buffer_load_dwordx4 v[40:43], v1, s[20:23], s53 offen offset:0 sc1
    s_waitcnt vmcnt(11)
    v_mfma_f32_16x16x32_bf16 v[84:87], v[200:203], v[44:47], v[84:87]
    v_mfma_f32_16x16x32_bf16 v[100:103], v[204:207], v[44:47], v[100:103]
    v_mfma_f32_16x16x32_bf16 v[116:119], v[208:211], v[44:47], v[116:119]
    v_mfma_f32_16x16x32_bf16 v[132:135], v[212:215], v[44:47], v[132:135]
    v_mfma_f32_16x16x32_bf16 v[148:151], v[216:219], v[44:47], v[148:151]
    buffer_load_dwordx4 v[44:47], v1, s[20:23], s53 offen offset:1024 sc1
    s_waitcnt vmcnt(11)
    v_mfma_f32_16x16x32_bf16 v[88:91], v[200:203], v[48:51], v[88:91]
    ds_read_b128 v[240:243], v5 offset:0
    v_mfma_f32_16x16x32_bf16 v[104:107], v[204:207], v[48:51], v[104:107]
    ds_read_b128 v[244:247], v5 offset:1024
    v_mfma_f32_16x16x32_bf16 v[120:123], v[208:211], v[48:51], v[120:123]
    ds_read_b128 v[248:251], v5 offset:2048
    v_mfma_f32_16x16x32_bf16 v[136:139], v[212:215], v[48:51], v[136:139]
    ds_read_b128 v[252:255], v5 offset:3072
    v_mfma_f32_16x16x32_bf16 v[152:155], v[216:219], v[48:51], v[152:155]
    ds_read_b128 v[56:59], v5 offset:4096
    buffer_load_dwordx4 v[48:51], v1, s[20:23], s53 offen offset:2048 sc1
    s_waitcnt vmcnt(11)
    v_mfma_f32_16x16x32_bf16 v[92:95], v[200:203], v[52:55], v[92:95]
    v_mfma_f32_16x16x32_bf16 v[108:111], v[204:207], v[52:55], v[108:111]
    v_mfma_f32_16x16x32_bf16 v[124:127], v[208:211], v[52:55], v[124:127]
    v_mfma_f32_16x16x32_bf16 v[140:143], v[212:215], v[52:55], v[140:143]
    v_mfma_f32_16x16x32_bf16 v[156:159], v[216:219], v[52:55], v[156:159]
    buffer_load_dwordx4 v[52:55], v1, s[20:23], s53 offen offset:3072 sc1
    s_add_u32 s53, s53, 4096
    s_waitcnt vmcnt(11) lgkmcnt(5)
    v_mfma_f32_16x16x32_bf16 v[80:83], v[220:223], v[8:11], v[80:83]
    v_mfma_f32_16x16x32_bf16 v[96:99], v[224:227], v[8:11], v[96:99]
    v_mfma_f32_16x16x32_bf16 v[112:115], v[228:231], v[8:11], v[112:115]
    v_mfma_f32_16x16x32_bf16 v[128:131], v[232:235], v[8:11], v[128:131]
    v_mfma_f32_16x16x32_bf16 v[144:147], v[236:239], v[8:11], v[144:147]
    s_waitcnt vmcnt(10)
    v_mfma_f32_16x16x32_bf16 v[84:87], v[220:223], v[12:15], v[84:87]
    v_mfma_f32_16x16x32_bf16 v[100:103], v[224:227], v[12:15], v[100:103]
    v_mfma_f32_16x16x32_bf16 v[116:119], v[228:231], v[12:15], v[116:119]
    v_mfma_f32_16x16x32_bf16 v[132:135], v[232:235], v[12:15], v[132:135]
    v_mfma_f32_16x16x32_bf16 v[148:151], v[236:239], v[12:15], v[148:151]
    s_waitcnt vmcnt(9)
    v_mfma_f32_16x16x32_bf16 v[88:91], v[220:223], v[16:19], v[88:91]
    ds_read_b128 v[60:63], v5 offset:5120
    v_mfma_f32_16x16x32_bf16 v[104:107], v[224:227], v[16:19], v[104:107]
    ds_read_b128 v[64:67], v5 offset:6144
    v_mfma_f32_16x16x32_bf16 v[120:123], v[228:231], v[16:19], v[120:123]
    ds_read_b128 v[68:71], v5 offset:7168
    v_mfma_f32_16x16x32_bf16 v[136:139], v[232:235], v[16:19], v[136:139]
    ds_read_b128 v[72:75], v5 offset:8192
    v_mfma_f32_16x16x32_bf16 v[152:155], v[236:239], v[16:19], v[152:155]
    ds_read_b128 v[76:79], v5 offset:9216
    s_waitcnt vmcnt(8)
    v_mfma_f32_16x16x32_bf16 v[92:95], v[220:223], v[20:23], v[92:95]
    v_mfma_f32_16x16x32_bf16 v[108:111], v[224:227], v[20:23], v[108:111]
    v_mfma_f32_16x16x32_bf16 v[124:127], v[228:231], v[20:23], v[124:127]
    v_mfma_f32_16x16x32_bf16 v[140:143], v[232:235], v[20:23], v[140:143]
    v_mfma_f32_16x16x32_bf16 v[156:159], v[236:239], v[20:23], v[156:159]
    s_waitcnt vmcnt(7) lgkmcnt(5)
    v_mfma_f32_16x16x32_bf16 v[80:83], v[240:243], v[24:27], v[80:83]
    v_mfma_f32_16x16x32_bf16 v[96:99], v[244:247], v[24:27], v[96:99]
    v_mfma_f32_16x16x32_bf16 v[112:115], v[248:251], v[24:27], v[112:115]
    v_mfma_f32_16x16x32_bf16 v[128:131], v[252:255], v[24:27], v[128:131]
    v_mfma_f32_16x16x32_bf16 v[144:147], v[56:59], v[24:27], v[144:147]
    s_waitcnt vmcnt(6)
    v_mfma_f32_16x16x32_bf16 v[84:87], v[240:243], v[28:31], v[84:87]
    v_mfma_f32_16x16x32_bf16 v[100:103], v[244:247], v[28:31], v[100:103]
    v_mfma_f32_16x16x32_bf16 v[116:119], v[248:251], v[28:31], v[116:119]
    v_mfma_f32_16x16x32_bf16 v[132:135], v[252:255], v[28:31], v[132:135]
    v_mfma_f32_16x16x32_bf16 v[148:151], v[56:59], v[28:31], v[148:151]
    s_waitcnt vmcnt(5)
    v_mfma_f32_16x16x32_bf16 v[88:91], v[240:243], v[32:35], v[88:91]
    v_mfma_f32_16x16x32_bf16 v[104:107], v[244:247], v[32:35], v[104:107]
    v_mfma_f32_16x16x32_bf16 v[120:123], v[248:251], v[32:35], v[120:123]
    v_mfma_f32_16x16x32_bf16 v[136:139], v[252:255], v[32:35], v[136:139]
    v_mfma_f32_16x16x32_bf16 v[152:155], v[56:59], v[32:35], v[152:155]
    s_waitcnt vmcnt(4)
    v_mfma_f32_16x16x32_bf16 v[92:95], v[240:243], v[36:39], v[92:95]
    v_mfma_f32_16x16x32_bf16 v[108:111], v[244:247], v[36:39], v[108:111]
    v_mfma_f32_16x16x32_bf16 v[124:127], v[248:251], v[36:39], v[124:127]
    v_mfma_f32_16x16x32_bf16 v[140:143], v[252:255], v[36:39], v[140:143]
    v_mfma_f32_16x16x32_bf16 v[156:159], v[56:59], v[36:39], v[156:159]
    s_waitcnt vmcnt(3) lgkmcnt(0)
    v_mfma_f32_16x16x32_bf16 v[80:83], v[60:63], v[40:43], v[80:83]
    v_mfma_f32_16x16x32_bf16 v[96:99], v[64:67], v[40:43], v[96:99]
    v_mfma_f32_16x16x32_bf16 v[112:115], v[68:71], v[40:43], v[112:115]
    v_mfma_f32_16x16x32_bf16 v[128:131], v[72:75], v[40:43], v[128:131]
    v_mfma_f32_16x16x32_bf16 v[144:147], v[76:79], v[40:43], v[144:147]
    s_nop 0
    s_waitcnt vmcnt(2)
    v_mfma_f32_16x16x32_bf16 v[84:87], v[60:63], v[44:47], v[84:87]
    v_mfma_f32_16x16x32_bf16 v[100:103], v[64:67], v[44:47], v[100:103]
    v_mfma_f32_16x16x32_bf16 v[116:119], v[68:71], v[44:47], v[116:119]
    v_cvt_pk_bf16_f32 v8, v80, v81
    v_cvt_pk_bf16_f32 v9, v82, v83
    v_mfma_f32_16x16x32_bf16 v[132:135], v[72:75], v[44:47], v[132:135]
    v_cvt_pk_bf16_f32 v10, v96, v97
    v_cvt_pk_bf16_f32 v11, v98, v99
    v_mfma_f32_16x16x32_bf16 v[148:151], v[76:79], v[44:47], v[148:151]
    ds_write_b64 v2, v[8:9] offset:0
    v_cvt_pk_bf16_f32 v12, v112, v113
    s_nop 0
    s_waitcnt vmcnt(1)
    v_mfma_f32_16x16x32_bf16 v[88:91], v[60:63], v[48:51], v[88:91]
    v_cvt_pk_bf16_f32 v13, v114, v115
    ds_write_b64 v2, v[10:11] offset:32
    v_mfma_f32_16x16x32_bf16 v[104:107], v[64:67], v[48:51], v[104:107]
    v_cvt_pk_bf16_f32 v14, v128, v129
    v_cvt_pk_bf16_f32 v15, v130, v131
    v_mfma_f32_16x16x32_bf16 v[120:123], v[68:71], v[48:51], v[120:123]
    ds_write_b64 v2, v[12:13] offset:64
    v_cvt_pk_bf16_f32 v16, v144, v145
    v_mfma_f32_16x16x32_bf16 v[136:139], v[72:75], v[48:51], v[136:139]
    v_cvt_pk_bf16_f32 v17, v146, v147
    ds_write_b64 v2, v[14:15] offset:96
    v_mfma_f32_16x16x32_bf16 v[152:155], v[76:79], v[48:51], v[152:155]
    v_cvt_pk_bf16_f32 v18, v84, v85
    v_cvt_pk_bf16_f32 v19, v86, v87
    s_nop 0
    s_waitcnt vmcnt(0)
    v_mfma_f32_16x16x32_bf16 v[92:95], v[60:63], v[52:55], v[92:95]
    ds_write_b64 v2, v[16:17] offset:128
    v_cvt_pk_bf16_f32 v20, v100, v101
    v_mfma_f32_16x16x32_bf16 v[108:111], v[64:67], v[52:55], v[108:111]
    v_cvt_pk_bf16_f32 v21, v102, v103
    ds_write_b64 v2, v[18:19] offset:2816
    v_mfma_f32_16x16x32_bf16 v[124:127], v[68:71], v[52:55], v[124:127]
    v_cvt_pk_bf16_f32 v22, v116, v117
    v_cvt_pk_bf16_f32 v23, v118, v119
    v_mfma_f32_16x16x32_bf16 v[140:143], v[72:75], v[52:55], v[140:143]
    ds_write_b64 v2, v[20:21] offset:2848
    v_cvt_pk_bf16_f32 v24, v132, v133
    v_mfma_f32_16x16x32_bf16 v[156:159], v[76:79], v[52:55], v[156:159]
    v_cvt_pk_bf16_f32 v25, v134, v135
    ds_write_b64 v2, v[22:23] offset:2880
    s_nop 3
    s_nop 0
    v_cvt_pk_bf16_f32 v26, v148, v149
    v_cvt_pk_bf16_f32 v27, v150, v151
    ds_write_b64 v2, v[24:25] offset:2912
    v_cvt_pk_bf16_f32 v28, v88, v89
    v_cvt_pk_bf16_f32 v29, v90, v91
    ds_write_b64 v2, v[26:27] offset:2944
    v_cvt_pk_bf16_f32 v30, v104, v105
    v_cvt_pk_bf16_f32 v31, v106, v107
    ds_write_b64 v2, v[28:29] offset:41024
    v_cvt_pk_bf16_f32 v32, v120, v121
    v_cvt_pk_bf16_f32 v33, v122, v123
    ds_write_b64 v2, v[30:31] offset:41056
    v_cvt_pk_bf16_f32 v34, v136, v137
    v_cvt_pk_bf16_f32 v35, v138, v139
    ds_write_b64 v2, v[32:33] offset:41088
    v_cvt_pk_bf16_f32 v36, v152, v153
    v_cvt_pk_bf16_f32 v37, v154, v155
    ds_write_b64 v2, v[34:35] offset:41120
    v_cvt_pk_bf16_f32 v38, v92, v93
    v_cvt_pk_bf16_f32 v39, v94, v95
    ds_write_b64 v2, v[36:37] offset:41152
    v_cvt_pk_bf16_f32 v8, v108, v109
    v_cvt_pk_bf16_f32 v9, v110, v111
    ds_write_b64 v2, v[38:39] offset:43840
    v_cvt_pk_bf16_f32 v10, v124, v125
    v_cvt_pk_bf16_f32 v11, v126, v127
    ds_write_b64 v2, v[8:9] offset:43872
    v_cvt_pk_bf16_f32 v12, v140, v141
    v_cvt_pk_bf16_f32 v13, v142, v143
    ds_write_b64 v2, v[10:11] offset:43904
    v_cvt_pk_bf16_f32 v14, v156, v157
    v_cvt_pk_bf16_f32 v15, v158, v159
    ds_write_b64 v2, v[12:13] offset:43936
    ds_write_b64 v2, v[14:15] offset:43968
k_post:
    s_mov_b32 s16, s56
    s_mov_b32 s17, s57
    s_mov_b32 s18, 2621440
    s_mov_b32 s19, 0x20000
    s_mul_i32 s24, s6, 81920
    s_mul_i32 s25, s7, 160
    s_add_u32 s24, s24, s25
    s_lshl_b32 s27, s3, 6
    v_add_u32_e64 v40, s27, v0
    v_mul_u32_u24 v41, 6554, v40
    v_lshrrev_b32 v41, 16, v41
    v_mul_u32_u24 v42, 10, v41
    v_sub_u32_e64 v42, v40, v42
    v_mul_u32_u24 v43, 1280, v41
    v_lshl_add_u32 v43, v42, 4, v43
    v_mul_u32_u24 v44, 176, v41
    v_lshl_add_u32 v44, v42, 4, v44
    v_lshrrev_b32_e64 v45, 5, v41
    v_mul_u32_u24 v45, 35392, v45
    v_add_u32_e64 v44, v44, v45
    v_mul_u32_u24 v45, 86, v42
    v_lshrrev_b32_e64 v45, 8, v45
    v_mul_u32_u24 v46, 13232, v42
    v_mul_u32_u24 v45, 38624, v45
    v_sub_u32_e64 v46, v46, v45
    v_lshl_add_u32 v46, v41, 4, v46
    v_add_u32 v46, 127168, v46
    v_lshlrev_b32_e64 v47, 4, v41
    v_add_u32 v47, 131776, v47
    v_pk_mov_b32 v[160:161], 0, 0
    v_pk_mov_b32 v[162:163], 0, 0
    v_pk_mov_b32 v[164:165], 0, 0
    v_pk_mov_b32 v[166:167], 0, 0
    s_and_b32 s28, s3, 6
    s_cmp_lg_u32 s28, 4
    s_cbranch_scc1 po_22
    s_add_u32 s27, s27, 256
    s_setprio 3
    v_add_u32_e64 v48, s27, v0
    v_mul_u32_u24 v49, 6554, v48
    v_lshrrev_b32 v49, 16, v49
    v_mul_u32_u24 v50, 10, v49
    v_sub_u32_e64 v50, v48, v50
    v_mul_u32_u24 v51, 1280, v49
    v_lshl_add_u32 v51, v50, 4, v51
    v_mul_u32_u24 v52, 176, v49
    v_lshl_add_u32 v52, v50, 4, v52
    v_lshrrev_b32_e64 v53, 5, v49
    v_mul_u32_u24 v53, 35392, v53
    v_add_u32_e64 v52, v52, v53
    v_mul_u32_u24 v53, 86, v50
    v_lshrrev_b32_e64 v53, 8, v53
    v_mul_u32_u24 v54, 13232, v50
    v_mul_u32_u24 v53, 38624, v53
    v_sub_u32_e64 v54, v54, v53
    v_lshl_add_u32 v54, v49, 4, v54
    v_add_u32 v54, 127168, v54
    v_lshlrev_b32_e64 v55, 4, v49
    v_add_u32 v55, 131776, v55
    v_pk_mov_b32 v[168:169], 0, 0
    v_pk_mov_b32 v[170:171], 0, 0
    v_pk_mov_b32 v[172:173], 0, 0
    v_pk_mov_b32 v[174:175], 0, 0
po_22:
    s_waitcnt lgkmcnt(0)
    s_barrier
    s_cmp_lg_u32 s28, 4
    s_cbranch_scc1 po_24
    ds_read_b128 v[252:255], v55
    ds_read_b128 v[232:235], v52 offset:0
    ds_read_b128 v[236:239], v52 offset:10240
    ds_read_b128 v[240:243], v52 offset:20480
    ds_read_b128 v[244:247], v52 offset:30720
    ds_read_b128 v[248:251], v54
po_24:
    ds_read_b128 v[228:231], v47
    ds_read_b128 v[208:211], v44 offset:0
    ds_read_b128 v[212:215], v44 offset:10240
    ds_read_b128 v[216:219], v44 offset:20480
    ds_read_b128 v[220:223], v44 offset:30720
    ds_read_b128 v[224:227], v46
    s_waitcnt lgkmcnt(4)
    v_dot2c_f32_bf16 v160, v208, v228
    v_dot2c_f32_bf16 v161, v208, v229
    v_dot2c_f32_bf16 v162, v209, v228
    v_dot2c_f32_bf16 v163, v209, v229
    v_dot2c_f32_bf16 v164, v210, v228
    v_dot2c_f32_bf16 v165, v210, v229
    v_dot2c_f32_bf16 v166, v211, v228
    v_dot2c_f32_bf16 v167, v211, v229
    s_waitcnt lgkmcnt(3)
    v_dot2c_f32_bf16 v160, v212, v228
    v_dot2c_f32_bf16 v161, v212, v229
    v_dot2c_f32_bf16 v162, v213, v228
    v_dot2c_f32_bf16 v163, v213, v229
    v_dot2c_f32_bf16 v164, v214, v228
    v_dot2c_f32_bf16 v165, v214, v229
    v_dot2c_f32_bf16 v166, v215, v228
    v_dot2c_f32_bf16 v167, v215, v229
    s_waitcnt lgkmcnt(2)
    v_dot2c_f32_bf16 v160, v216, v228
    v_dot2c_f32_bf16 v161, v216, v229
    v_dot2c_f32_bf16 v162, v217, v228
    v_dot2c_f32_bf16 v163, v217, v229
    v_dot2c_f32_bf16 v164, v218, v228
    v_dot2c_f32_bf16 v165, v218, v229
    v_dot2c_f32_bf16 v166, v219, v228
    v_dot2c_f32_bf16 v167, v219, v229
    s_waitcnt lgkmcnt(1)
    v_dot2c_f32_bf16 v160, v220, v228
    v_dot2c_f32_bf16 v161, v220, v229
    v_dot2c_f32_bf16 v162, v221, v228
    v_dot2c_f32_bf16 v163, v221, v229
    v_dot2c_f32_bf16 v164, v222, v228
    v_dot2c_f32_bf16 v165, v222, v229
    v_dot2c_f32_bf16 v166, v223, v228
    v_dot2c_f32_bf16 v167, v223, v229
    s_waitcnt lgkmcnt(0)
    v_dot2c_f32_bf16 v160, v224, v230
    v_dot2c_f32_bf16 v161, v224, v231
    v_dot2c_f32_bf16 v162, v225, v230
    v_dot2c_f32_bf16 v163, v225, v231
    v_dot2c_f32_bf16 v164, v226, v230
    v_dot2c_f32_bf16 v165, v226, v231
    v_dot2c_f32_bf16 v166, v227, v230
    v_dot2c_f32_bf16 v167, v227, v231
    s_nop 0
    v_cvt_pk_bf16_f32 v208, v160, v161
    v_cvt_pk_bf16_f32 v209, v162, v163
    v_cvt_pk_bf16_f32 v210, v164, v165
    v_cvt_pk_bf16_f32 v211, v166, v167
    buffer_store_dwordx4 v[208:211], v43, s[16:19], s24 offen
    s_cmp_lg_u32 s28, 4
    s_cbranch_scc1 po_23
    s_waitcnt lgkmcnt(4)
    v_dot2c_f32_bf16 v168, v232, v252
    v_dot2c_f32_bf16 v169, v232, v253
    v_dot2c_f32_bf16 v170, v233, v252
    v_dot2c_f32_bf16 v171, v233, v253
    v_dot2c_f32_bf16 v172, v234, v252
    v_dot2c_f32_bf16 v173, v234, v253
    v_dot2c_f32_bf16 v174, v235, v252
    v_dot2c_f32_bf16 v175, v235, v253
    s_waitcnt lgkmcnt(3)
    v_dot2c_f32_bf16 v168, v236, v252
    v_dot2c_f32_bf16 v169, v236, v253
    v_dot2c_f32_bf16 v170, v237, v252
    v_dot2c_f32_bf16 v171, v237, v253
    v_dot2c_f32_bf16 v172, v238, v252
    v_dot2c_f32_bf16 v173, v238, v253
    v_dot2c_f32_bf16 v174, v239, v252
    v_dot2c_f32_bf16 v175, v239, v253
    s_waitcnt lgkmcnt(2)
    v_dot2c_f32_bf16 v168, v240, v252
    v_dot2c_f32_bf16 v169, v240, v253
    v_dot2c_f32_bf16 v170, v241, v252
    v_dot2c_f32_bf16 v171, v241, v253
    v_dot2c_f32_bf16 v172, v242, v252
    v_dot2c_f32_bf16 v173, v242, v253
    v_dot2c_f32_bf16 v174, v243, v252
    v_dot2c_f32_bf16 v175, v243, v253
    s_waitcnt lgkmcnt(1)
    v_dot2c_f32_bf16 v168, v244, v252
    v_dot2c_f32_bf16 v169, v244, v253
    v_dot2c_f32_bf16 v170, v245, v252
    v_dot2c_f32_bf16 v171, v245, v253
    v_dot2c_f32_bf16 v172, v246, v252
    v_dot2c_f32_bf16 v173, v246, v253
    v_dot2c_f32_bf16 v174, v247, v252
    v_dot2c_f32_bf16 v175, v247, v253
    s_waitcnt lgkmcnt(0)
    v_dot2c_f32_bf16 v168, v248, v254
    v_dot2c_f32_bf16 v169, v248, v255
    v_dot2c_f32_bf16 v170, v249, v254
    v_dot2c_f32_bf16 v171, v249, v255
    v_dot2c_f32_bf16 v172, v250, v254
    v_dot2c_f32_bf16 v173, v250, v255
    v_dot2c_f32_bf16 v174, v251, v254
    v_dot2c_f32_bf16 v175, v251, v255
    s_nop 0
    v_cvt_pk_bf16_f32 v232, v168, v169
    v_cvt_pk_bf16_f32 v233, v170, v171
    v_cvt_pk_bf16_f32 v234, v172, v173
    v_cvt_pk_bf16_f32 v235, v174, v175
    buffer_store_dwordx4 v[232:235], v51, s[16:19], s24 offen
po_23:
k_end:
    s_endpgm
k_h:
    s_mov_b32 s47, s13
    s_lshr_b32 s8, s97, 1
    s_lshl_b32 s8, s8, 3
    s_add_u32 s8, s8, s96
    s_add_u32 s8, s8, 240
    s_and_b32 s9, s97, 1
    s_cselect_b32 s8, s8, 999
    s_cmp_eq_u32 s100, 0
    s_cselect_b32 s8, s2, s8
    s_cmp_ge_u32 s2, 240
    s_cselect_b32 s8, 999, s8
    s_cmp_eq_u32 s100, 1
    s_cselect_b32 s8, 999, s8
    s_cselect_b32 s9, s2, 999
    v_add_u32 v39, s101, v1
    s_mul_i32 s19, s18, 3072
    s_add_u32 s19, s19, 11771904
    s_lshl_b32 s18, s18, 7
    s_add_u32 s18, s18, 11755520
    s_cmp_eq_u32 s16, 0
    s_cbranch_scc0 if_25
    buffer_store_dwordx4 v[20:23], v1, s[20:23], s19 offen offset:0 sc1
    buffer_store_dwordx4 v[24:27], v1, s[20:23], s19 offen offset:1024 sc1
    buffer_store_dwordx4 v[28:31], v1, s[20:23], s19 offen offset:2048 sc1
if_25:
    s_barrier
    v_lshlrev_b32_e64 v33, 2, v0
    v_add_u32 v33, 163000, v33
    ds_read_b32 v32, v33
    ds_read_b128 v[120:123], v39 offset:4352
    ds_read_b128 v[124:127], v39 offset:5376
    ds_read_b128 v[128:131], v39 offset:6400
    ds_read_b128 v[132:135], v39 offset:8704
    ds_read_b128 v[136:139], v39 offset:9728
    ds_read_b128 v[140:143], v39 offset:10752
    s_waitcnt lgkmcnt(0)
    s_cmp_ge_u32 s16, 1
    s_cbranch_scc0 if_26
    v_add_f32 v20, v20, v120
    v_add_f32 v21, v21, v121
    v_add_f32 v22, v22, v122
    v_add_f32 v23, v23, v123
    v_add_f32 v24, v24, v124
    v_add_f32 v25, v25, v125
    v_add_f32 v26, v26, v126
    v_add_f32 v27, v27, v127
    v_add_f32 v28, v28, v128
    v_add_f32 v29, v29, v129
    v_add_f32 v30, v30, v130
    v_add_f32 v31, v31, v131
if_26:
    s_cmp_ge_u32 s16, 2
    s_cbranch_scc0 if_27
    v_add_f32 v20, v20, v132
    v_add_f32 v21, v21, v133
    v_add_f32 v22, v22, v134
    v_add_f32 v23, v23, v135
    v_add_f32 v24, v24, v136
    v_add_f32 v25, v25, v137
    v_add_f32 v26, v26, v138
    v_add_f32 v27, v27, v139
    v_add_f32 v28, v28, v140
    v_add_f32 v29, v29, v141
    v_add_f32 v30, v30, v142
    v_add_f32 v31, v31, v143
if_27:
    s_barrier
    s_load_dword s61, s[58:59], 0
    s_mov_b32 s62, 0
    s_waitcnt lgkmcnt(0)
tg_28:
    s_cmp_lg_u32 s61, 0
    s_cbranch_scc1 tg_29
    v_mov_b32_e64 v40, 0
    global_load_dword v40, v40, s[58:59] sc1
    s_addk_i32 s62, 1
    s_waitcnt vmcnt(0)
    v_readfirstlane_b32 s61, v40
    s_sleep 1
    s_cmpk_lt_u32 s62, 0x3000
    s_cbranch_scc1 tg_28
tg_29:
    s_waitcnt vmcnt(0)
    s_cmp_lt_u32 s8, 320
    s_cbranch_scc0 if_30
    s_lshr_b32 s26, s8, 5
    s_lshl_b32 s26, s26, 8
    s_and_b32 s27, s8, 31
    s_lshl_b32 s27, s27, 2
    s_add_u32 s26, s26, s27
    s_add_u32 s26, s26, 11583488
    v_mov_b32 v146, s61
    v_mul_u32_u24 v147, 0, v0
    s_mov_b64 exec, 1
    s_waitcnt vmcnt(0)
    buffer_store_dword v146, v147, s[20:23], s26 offen sc1
    s_mov_b64 exec, -1
if_30:
    s_cmp_eq_u32 s16, 0
    s_cbranch_scc0 if_31
    v_mov_b32 v146, s61
    v_mul_u32_u24 v147, 0, v0
    s_mov_b64 exec, 1
    buffer_store_dword v146, v147, s[20:23], s18 offen sc1
    s_mov_b64 exec, -1
if_31:
    s_cmp_lt_u32 s9, 240
    s_cbranch_scc0 if_32
    s_mul_i32 s26, s9, 2731
    s_lshr_b32 s26, s26, 16
    s_mul_i32 s26, s26, 160
    s_lshl_b32 s27, s9, 2
    s_add_u32 s26, s26, s27
    s_add_u32 s26, s26, 11751424
    v_mov_b32 v146, s61
    v_mul_u32_u24 v147, 0, v0
    s_mov_b64 exec, 1
    s_waitcnt vmcnt(0)
    buffer_store_dword v146, v147, s[20:23], s26 offen sc1
    s_mov_b64 exec, -1
if_32:
    s_cmp_eq_u32 s100, 2
    s_cbranch_scc0 if_33
    s_mov_b32 s13, 0xbfb8aa3b
    s_nop 1
    v_add_f32_dpp v32, v32, v32 quad_perm:[1,0,3,2] row_mask:0xf bank_mask:0xf
    s_nop 1
    v_add_f32_dpp v32, v32, v32 quad_perm:[2,3,0,1] row_mask:0xf bank_mask:0xf
    s_nop 1
    v_add_f32_dpp v32, v32, v32 row_half_mirror row_mask:0xf bank_mask:0xf
    v_mul_f32 v32, s13, v32
    v_exp_f32 v32, v32
    v_mov_b32 v33, s61
    v_add_f32 v32, 1.0, v32
    v_rcp_f32 v32, v32
    s_lshl_b32 s15, s2, 6
    s_add_u32 s15, s15, 11534336
    s_mov_b32 exec_lo, 0x01010101
    s_mov_b32 exec_hi, 0x01010101
    buffer_store_dwordx2 v[32:33], v0, s[20:23], s15 offen sc1
    s_mov_b64 exec, -1
if_33:
    s_barrier
    v_lshlrev_b32 v2, 4, v18
    v_lshlrev_b32 v6, 5, v17
    v_sub_u32_e64 v2, v2, v6
    v_add_u32 v2, 8928, v2
    v_add_u32 v2, s101, v2
    v_sub_u32 v6, 15, v17
    v_and_b32 v7, 1, v6
    v_sub_u32 v6, v6, v7
    v_mul_u32_u24 v3, 4160, v7
    v_lshl_add_u32 v3, v18, 4, v3
    v_lshlrev_b32 v6, 1, v6
    v_sub_u32 v3, v3, v6
    v_add_u32 v3, 64, v3
    v_add_u32 v3, s101, v3
    v_add_u32 v4, 1024, v3
    v_add_u32 v5, 2048, v3
    v_add_u32 v6, 3072, v3
    v_lshlrev_b32 v7, 5, v17
    v_lshrrev_b32 v8, 1, v18
    v_lshl_add_u32 v7, v8, 4, v7
    v_and_b32_e64 v8, 1, v18
    v_lshl_add_u32 v7, v8, 9, v7
    v_and_b32 v144, 31, v0
    v_lshlrev_b32 v144, 2, v144
    s_lshr_b32 s29, s60, 6
    s_lshl_b32 s29, s29, 8
    s_add_u32 s29, s29, 11583488
    s_lshl_b32 s31, s60, 12
    s_add_u32 s30, s31, 6291456
    s_add_u32 m0, s101, 8448
    s_barrier
    v_add_u32 v39, s101, v1
    v_lshlrev_b32 v40, 4, v17
    v_add_u32_e64 v40, s101, v40
    v_lshl_add_u32 v41, v18, 10, v40
    v_add_u32 v41, 2104, v41
    v_and_b32 v42, 1, v0
    v_lshlrev_b32 v42, 3, v42
    v_sub_u32_e64 v42, v41, v42
    v_lshl_add_u32 v43, v18, 9, v40
    v_lshl_add_u32 v44, v18, 8, v40
    v_lshrrev_b32_e64 v45, 1, v18
    v_lshl_add_u32 v45, v45, 8, v40
    v_and_b32_e64 v46, 1, v18
    v_lshl_add_u32 v45, v46, 3, v45
    v_mov_b32 v34, 0
    v_mov_b32 v35, 0
    v_and_b32 v46, 7, v0
    v_lshlrev_b32 v46, 2, v46
    v_add_u32 v46, s101, v46
    v_lshlrev_b32 v47, 3, v0
    v_add_u32 v47, s101, v47
    s_barrier
    v_mov_b32 v172, 0
    v_mov_b32 v173, 0
    v_mov_b32 v174, 0
    v_mov_b32 v175, 0
    v_mov_b32 v176, 0
    v_mov_b32 v177, 0
    v_mov_b32 v178, 0
    v_mov_b32 v179, 0
    v_mov_b32 v180, 0
    v_mov_b32 v181, 0
    v_mov_b32 v182, 0
    v_mov_b32 v183, 0
    v_mov_b32 v184, 0
    v_mov_b32 v185, 0
    v_mov_b32 v186, 0
    v_mov_b32 v187, 0
    v_mov_b32 v188, 0
    v_mov_b32 v189, 0
    v_mov_b32 v190, 0
    v_mov_b32 v191, 0
    v_mov_b32 v192, 0
    v_mov_b32 v193, 0
    v_mov_b32 v194, 0
    v_mov_b32 v195, 0
    v_mov_b32 v196, 0
    v_mov_b32 v197, 0
    v_mov_b32 v198, 0
    v_mov_b32 v199, 0
    v_mov_b32 v200, 0
    v_mov_b32 v201, 0
    v_mov_b32 v202, 0
    v_mov_b32 v203, 0
    s_barrier
    v_mov_b32 v150, 0
    s_barrier
    s_cmp_eq_u32 s100, 0
    s_cbranch_scc0 if_34
    v_min_u32 v150, 47, v0
    v_cmp_lt_u32 vcc, 23, v150
    v_lshlrev_b32 v150, 2, v150
    v_add_u32 v151, 160, v150
    v_cndmask_b32 v150, v150, v151, vcc
    s_mul_i32 s26, s7, 5
    s_lshr_b32 s26, s26, 2
    s_lshl_b32 s26, s26, 8
    s_add_u32 s26, s26, 11751424
    buffer_load_dword v151, v150, s[20:23], s26 offen sc1
    s_waitcnt vmcnt(0)
    v_cmp_ne_u32 vcc, s61, v151
    s_cbranch_vccz ok_35
    s_mov_b32 s62, 0
pl_36:
    buffer_load_dword v151, v150, s[20:23], s26 offen sc1
    s_addk_i32 s62, 1
    s_waitcnt vmcnt(0)
    v_cmp_ne_u32 vcc, s61, v151
    s_cbranch_vccz pl_37
    s_sleep 1
    s_cmpk_lt_u32 s62, 0x3000
    s_cbranch_scc1 pl_36
pl_37:
ok_35:
if_34:
    s_barrier
    buffer_load_dword v145, v144, s[20:23], s29 offen sc1
    v_mov_b32 v146, 0
    s_cmp_eq_u32 s47, 1
    s_cbranch_scc0 if_38
    buffer_load_dword v147, v146, s[20:23], s18 offen sc1
if_38:
    s_waitcnt vmcnt(0)
    s_cmp_eq_u32 s17, 0
    s_cbranch_scc0 if_39
    v_cmp_ne_u32 vcc, s61, v145
    s_cbranch_vccz ok_40
    s_mov_b32 s62, 0
pl_41:
    buffer_load_dword v145, v144, s[20:23], s29 offen sc1
    s_addk_i32 s62, 1
    s_waitcnt vmcnt(0)
    v_cmp_ne_u32 vcc, s61, v145
    s_cbranch_vccz pl_42
    s_sleep 1
    s_cmpk_lt_u32 s62, 0x3000
    s_cbranch_scc1 pl_41
pl_42:
ok_40:
    buffer_load_dwordx4 v1, s[20:23], s30 offen offset:0 sc1 lds
    buffer_load_dwordx4 v1, s[20:23], s30 offen offset:1024 sc1 lds
    buffer_load_dwordx4 v1, s[20:23], s30 offen offset:2048 sc1 lds
    buffer_load_dwordx4 v1, s[20:23], s30 offen offset:3072 sc1 lds
if_39:
    s_cmp_eq_u32 s47, 1
    s_cbranch_scc0 if_43
    v_cmp_ne_u32 vcc, s61, v147
    s_cbranch_vccz ok_44
    s_mov_b32 s62, 0
pl_45:
    buffer_load_dword v147, v146, s[20:23], s18 offen sc1
    s_addk_i32 s62, 1
    s_waitcnt vmcnt(0)
    v_cmp_ne_u32 vcc, s61, v147
    s_cbranch_vccz pl_46
    s_sleep 1
    s_cmpk_lt_u32 s62, 0x3000
    s_cbranch_scc1 pl_45
pl_46:
ok_44:
    buffer_load_dwordx4 v[120:123], v1, s[20:23], s19 offen offset:0 sc1
    buffer_load_dwordx4 v[124:127], v1, s[20:23], s19 offen offset:1024 sc1
    buffer_load_dwordx4 v[128:131], v1, s[20:23], s19 offen offset:2048 sc1
if_43:
    v_lshlrev_b32 v170, 3, v0
    s_lshl_b32 s24, s6, 9
    s_add_u32 s24, s24, 11534336
    buffer_load_dwordx2 v[168:169], v170, s[20:23], s24 offen sc1
    v_mov_b32 v8, 162624
    s_cmp_eq_u32 s16, 0
    s_cbranch_scc0 if_47
    v_subrev_u32 v2, 13184, v2
    v_subrev_u32 v3, 13184, v3
    v_subrev_u32 v4, 13184, v4
    s_mov_b32 s8, 1
    s_mov_b32 s9, 1
    s_add_u32 s10, s60, 2
    s_branch k_cl
if_47:
    s_cmp_eq_u32 s47, 1
    s_cbranch_scc0 if_48
    s_waitcnt vmcnt(1)
    v_add_f32 v20, v20, v120
    v_add_f32 v21, v21, v121
    v_add_f32 v22, v22, v122
    v_add_f32 v23, v23, v123
    v_add_f32 v24, v24, v124
    v_add_f32 v25, v25, v125
    v_add_f32 v26, v26, v126
    v_add_f32 v27, v27, v127
    v_add_f32 v28, v28, v128
    v_add_f32 v29, v29, v129
    v_add_f32 v30, v30, v130
    v_add_f32_e64 v31, v31, v131
if_48:
    v_cvt_pk_bf16_f32 v48, v28, v28
    v_mov_b32_e64 v49, v48
    v_cvt_pk_bf16_f32 v50, v29, v29
    v_mov_b32_e64 v51, v50
    v_cvt_pk_bf16_f32 v52, v30, v30
    v_mov_b32_e64 v53, v52
    v_cvt_pk_bf16_f32 v54, v31, v31
    v_mov_b32_e64 v55, v54
    v_cvt_pk_bf16_f32 v56, v24, v24
    v_cvt_pk_bf16_f32 v57, v24, v25
    v_cvt_pk_bf16_f32 v58, v25, v25
    v_cvt_pk_bf16_f32 v59, v26, v26
    v_cvt_pk_bf16_f32 v60, v26, v27
    v_cvt_pk_bf16_f32 v61, v27, v27
    v_cvt_pk_bf16_f32 v62, v25, v26
    v_cvt_pk_bf16_f32 v64, v20, v21
    v_cvt_pk_bf16_f32 v65, v22, v23
    s_mov_b32 s62, 0
lw_49:
    ds_read_b32 v9, v8 offset:40
    s_addk_i32 s62, 1
    s_waitcnt lgkmcnt(0)
    v_cmp_ne_u32 vcc, 0, v9
    s_cbranch_vccz lw_50
    s_cmpk_lt_u32 s62, 0x7000
    s_nop 0
    s_cbranch_scc1 lw_49
lw_50:
    ds_write2_b64 v41, v[48:49], v[48:49] offset0:0 offset1:1
    ds_write2_b64 v41, v[50:51], v[50:51] offset0:32 offset1:33
    ds_write2_b64 v41, v[52:53], v[52:53] offset0:64 offset1:65
    ds_write2_b64 v41, v[54:55], v[54:55] offset0:96 offset1:97
    ds_write_b16 v42, v48 offset:16
    ds_write_b16 v42, v50 offset:272
    ds_write_b16 v42, v52 offset:528
    ds_write_b16 v42, v54 offset:784
    s_mov_b32 exec_lo, 0
    ds_write2_b32 v43, v56, v56 offset0:15 offset1:16
    ds_write2_b32 v43, v57, v58 offset0:17 offset1:18
    ds_write2_b32 v43, v59, v59 offset0:79 offset1:80
    ds_write2_b32 v43, v60, v61 offset0:81 offset1:82
    s_mov_b32 exec_lo, -1
    s_mov_b32 exec_hi, 0
    ds_write_b16 v44, v56 offset:574
    ds_write2_b32 v44, v56, v62 offset0:144 offset1:145
    ds_write_b32 v44, v59 offset:584
    ds_write_b16 v44, v61 offset:588
    s_mov_b64 exec, -1
    ds_write_b64 v45, v[64:65] offset:64
    ds_write_b32 v46, v34 offset:32
    ds_write_b32 v46, v34 offset:4192
    ds_write_b64 v47, v[34:35] offset:12544
    ds_read_b128 v[80:83], v39 offset:64
    ds_read_b32 v72, v39 offset:60
    ds_read_b128 v[88:91], v39 offset:1088
    ds_read_b32 v73, v39 offset:1084
    ds_read_b128 v[96:99], v39 offset:2112
    ds_read_b32 v74, v39 offset:2108
    ds_read_b128 v[104:107], v39 offset:3136
    ds_read_b32 v75, v39 offset:3132
    s_nop 0
    s_waitcnt lgkmcnt(0)
    v_alignbit_b32 v84, v80, v72, 16
    v_alignbit_b32 v85, v81, v80, 16
    v_alignbit_b32 v86, v82, v81, 16
    v_alignbit_b32 v87, v83, v82, 16
    ds_write_b128 v39, v[84:87] offset:4224
    v_alignbit_b32 v92, v88, v73, 16
    v_alignbit_b32 v93, v89, v88, 16
    v_alignbit_b32 v94, v90, v89, 16
    v_alignbit_b32 v95, v91, v90, 16
    ds_write_b128 v39, v[92:95] offset:5248
    v_alignbit_b32 v100, v96, v74, 16
    v_alignbit_b32 v101, v97, v96, 16
    v_alignbit_b32 v102, v98, v97, 16
    v_alignbit_b32 v103, v99, v98, 16
    ds_write_b128 v39, v[100:103] offset:6272
    v_alignbit_b32 v108, v104, v75, 16
    v_alignbit_b32 v109, v105, v104, 16
    v_alignbit_b32 v110, v106, v105, 16
    v_alignbit_b32 v111, v107, v106, 16
    ds_write_b128 v39, v[108:111] offset:7296
    s_nop 0
    s_waitcnt vmcnt(0)
    ds_read2_b32 v[40:41], v3 offset0:0 offset1:1
    ds_read2_b32 v[42:43], v3 offset0:2 offset1:3
    ds_read_b128 v[100:103], v2 offset:0
    ds_read_b128 v[96:99], v2 offset:512
    ds_read_b128 v[92:95], v2 offset:1024
    ds_read_b128 v[88:91], v2 offset:1536
    ds_read2_b32 v[44:45], v3 offset0:128 offset1:129
    ds_read2_b32 v[46:47], v3 offset0:130 offset1:131
    ds_read_b128 v[84:87], v2 offset:2048
    ds_read2_b32 v[48:49], v4 offset0:0 offset1:1
    ds_read2_b32 v[50:51], v4 offset0:2 offset1:3
    ds_read_b128 v[80:83], v2 offset:2560
    ds_read2_b32 v[52:53], v4 offset0:128 offset1:129
    ds_read2_b32 v[54:55], v4 offset0:130 offset1:131
    ds_read_b128 v[76:79], v2 offset:3072
    ds_read2_b32 v[56:57], v5 offset0:0 offset1:1
    ds_read2_b32 v[58:59], v5 offset0:2 offset1:3
    ds_read_b128 v[72:75], v2 offset:3584
    ds_read2_b32 v[60:61], v5 offset0:128 offset1:129
    ds_read2_b32 v[62:63], v5 offset0:130 offset1:131
    ds_read2_b32 v[64:65], v6 offset0:0 offset1:1
    ds_read2_b32 v[66:67], v6 offset0:2 offset1:3
    ds_read2_b32 v[68:69], v6 offset0:128 offset1:129
    ds_read2_b32 v[70:71], v6 offset0:130 offset1:131
    s_waitcnt lgkmcnt(14)
    s_barrier
    s_setprio 1
    s_mov_b32 s28, 0
cv_51:
    s_nop 0
    s_waitcnt lgkmcnt(14)
    v_mfma_f32_16x16x32_bf16 v[200:203], v[40:43], v[100:103], v[200:203]
    ds_read2_b32 v[104:105], v3 offset0:16 offset1:17
    v_mfma_f32_16x16x32_bf16 v[196:199], v[40:43], v[96:99], v[196:199]
    ds_read2_b32 v[106:107], v3 offset0:18 offset1:19
    v_mfma_f32_16x16x32_bf16 v[192:195], v[40:43], v[92:95], v[192:195]
    ds_read_b128 v[164:167], v2 offset:64
    v_mfma_f32_16x16x32_bf16 v[188:191], v[40:43], v[88:91], v[188:191]
    ds_read_b128 v[160:163], v2 offset:576
    v_mfma_f32_16x16x32_bf16 v[200:203], v[44:47], v[96:99], v[200:203]
    ds_read_b128 v[156:159], v2 offset:1088
    v_mfma_f32_16x16x32_bf16 v[196:199], v[44:47], v[92:95], v[196:199]
    ds_read_b128 v[152:155], v2 offset:1600
    v_mfma_f32_16x16x32_bf16 v[192:195], v[44:47], v[88:91], v[192:195]
    ds_read2_b32 v[108:109], v3 offset0:144 offset1:145
    v_mfma_f32_16x16x32_bf16 v[188:191], v[44:47], v[84:87], v[188:191]
    ds_read2_b32 v[110:111], v3 offset0:146 offset1:147
    s_nop 0
    s_waitcnt lgkmcnt(14)
    v_mfma_f32_16x16x32_bf16 v[200:203], v[48:51], v[92:95], v[200:203]
    ds_read_b128 v[148:151], v2 offset:2112
    v_mfma_f32_16x16x32_bf16 v[196:199], v[48:51], v[88:91], v[196:199]
    ds_read2_b32 v[112:113], v4 offset0:16 offset1:17
    v_mfma_f32_16x16x32_bf16 v[192:195], v[48:51], v[84:87], v[192:195]
    ds_read2_b32 v[114:115], v4 offset0:18 offset1:19
    v_mfma_f32_16x16x32_bf16 v[188:191], v[48:51], v[80:83], v[188:191]
    ds_read_b128 v[144:147], v2 offset:2624
    v_mfma_f32_16x16x32_bf16 v[200:203], v[52:55], v[88:91], v[200:203]
    ds_read2_b32 v[116:117], v4 offset0:144 offset1:145
    v_mfma_f32_16x16x32_bf16 v[196:199], v[52:55], v[84:87], v[196:199]
    ds_read2_b32 v[118:119], v4 offset0:146 offset1:147
    v_mfma_f32_16x16x32_bf16 v[192:195], v[52:55], v[80:83], v[192:195]
    ds_read_b128 v[140:143], v2 offset:3136
    v_mfma_f32_16x16x32_bf16 v[188:191], v[52:55], v[76:79], v[188:191]
    ds_read2_b32 v[120:121], v5 offset0:16 offset1:17
    v_mfma_f32_16x16x32_bf16 v[200:203], v[56:59], v[84:87], v[200:203]
    ds_read2_b32 v[122:123], v5 offset0:18 offset1:19
    v_mfma_f32_16x16x32_bf16 v[196:199], v[56:59], v[80:83], v[196:199]
    ds_read_b128 v[136:139], v2 offset:3648
    v_mfma_f32_16x16x32_bf16 v[192:195], v[56:59], v[76:79], v[192:195]
    ds_read2_b32 v[124:125], v5 offset0:144 offset1:145
    v_mfma_f32_16x16x32_bf16 v[188:191], v[56:59], v[72:75], v[188:191]
    ds_read2_b32 v[126:127], v5 offset0:146 offset1:147
    s_nop 0
    s_waitcnt lgkmcnt(14)
    v_mfma_f32_16x16x32_bf16 v[200:203], v[60:63], v[80:83], v[200:203]
    ds_read2_b32 v[128:129], v6 offset0:16 offset1:17
    v_mfma_f32_16x16x32_bf16 v[196:199], v[60:63], v[76:79], v[196:199]
    ds_read2_b32 v[130:131], v6 offset0:18 offset1:19
    v_mfma_f32_16x16x32_bf16 v[192:195], v[60:63], v[72:75], v[192:195]
    ds_read2_b32 v[132:133], v6 offset0:144 offset1:145
    v_mfma_f32_16x16x32_bf16 v[200:203], v[64:67], v[76:79], v[200:203]
    ds_read2_b32 v[134:135], v6 offset0:146 offset1:147
    v_mfma_f32_16x16x32_bf16 v[196:199], v[64:67], v[72:75], v[196:199]
    s_add_u32 s28, s28, 1
    s_nop 0
    v_mfma_f32_16x16x32_bf16 v[200:203], v[68:71], v[72:75], v[200:203]
    v_mfma_f32_16x16x32_bf16 v[200:203], v[104:107], v[164:167], v[200:203]
    ds_read2_b32 v[40:41], v3 offset0:32 offset1:33
    ds_read2_b32 v[42:43], v3 offset0:34 offset1:35
    v_mfma_f32_16x16x32_bf16 v[196:199], v[104:107], v[160:163], v[196:199]
    ds_read_b128 v[100:103], v2 offset:128
    v_mfma_f32_16x16x32_bf16 v[192:195], v[104:107], v[156:159], v[192:195]
    ds_read_b128 v[96:99], v2 offset:640
    v_mfma_f32_16x16x32_bf16 v[188:191], v[104:107], v[152:155], v[188:191]
    ds_read_b128 v[92:95], v2 offset:1152
    s_nop 0
    s_waitcnt lgkmcnt(14)
    v_mfma_f32_16x16x32_bf16 v[200:203], v[108:111], v[160:163], v[200:203]
    ds_read_b128 v[88:91], v2 offset:1664
    v_mfma_f32_16x16x32_bf16 v[196:199], v[108:111], v[156:159], v[196:199]
    ds_read2_b32 v[44:45], v3 offset0:160 offset1:161
    v_mfma_f32_16x16x32_bf16 v[192:195], v[108:111], v[152:155], v[192:195]
    ds_read2_b32 v[46:47], v3 offset0:162 offset1:163
    ds_read_b128 v[84:87], v2 offset:2176
    v_mfma_f32_16x16x32_bf16 v[188:191], v[108:111], v[148:151], v[188:191]
    v_add_u32 v3, 128, v3
    v_mfma_f32_16x16x32_bf16 v[200:203], v[112:115], v[156:159], v[200:203]
    ds_read2_b32 v[48:49], v4 offset0:32 offset1:33
    v_mfma_f32_16x16x32_bf16 v[196:199], v[112:115], v[152:155], v[196:199]
    ds_read2_b32 v[50:51], v4 offset0:34 offset1:35
    v_mfma_f32_16x16x32_bf16 v[192:195], v[112:115], v[148:151], v[192:195]
    ds_read_b128 v[80:83], v2 offset:2688
    v_mfma_f32_16x16x32_bf16 v[188:191], v[112:115], v[144:147], v[188:191]
    ds_read2_b32 v[52:53], v4 offset0:160 offset1:161
    v_mfma_f32_16x16x32_bf16 v[200:203], v[116:119], v[152:155], v[200:203]
    ds_read2_b32 v[54:55], v4 offset0:162 offset1:163
    v_mfma_f32_16x16x32_bf16 v[196:199], v[116:119], v[148:151], v[196:199]
    ds_read_b128 v[76:79], v2 offset:3200
    v_add_u32 v4, 128, v4
    v_mfma_f32_16x16x32_bf16 v[192:195], v[116:119], v[144:147], v[192:195]
    ds_read2_b32 v[56:57], v5 offset0:32 offset1:33
    v_mfma_f32_16x16x32_bf16 v[188:191], v[116:119], v[140:143], v[188:191]
    ds_read2_b32 v[58:59], v5 offset0:34 offset1:35
    s_nop 0
    s_waitcnt lgkmcnt(14)
    v_mfma_f32_16x16x32_bf16 v[200:203], v[120:123], v[148:151], v[200:203]
    ds_read_b128 v[72:75], v2 offset:3712
    v_mfma_f32_16x16x32_bf16 v[196:199], v[120:123], v[144:147], v[196:199]
    v_add_u32 v2, 128, v2
    v_mfma_f32_16x16x32_bf16 v[192:195], v[120:123], v[140:143], v[192:195]
    ds_read2_b32 v[60:61], v5 offset0:160 offset1:161
    v_mfma_f32_16x16x32_bf16 v[188:191], v[120:123], v[136:139], v[188:191]
    ds_read2_b32 v[62:63], v5 offset0:162 offset1:163
    v_add_u32 v5, 128, v5
    v_mfma_f32_16x16x32_bf16 v[200:203], v[124:127], v[144:147], v[200:203]
    s_cmp_lt_u32 s28, 4
    s_nop 0
    v_mfma_f32_16x16x32_bf16 v[196:199], v[124:127], v[140:143], v[196:199]
    ds_read2_b32 v[64:65], v6 offset0:32 offset1:33
    v_mfma_f32_16x16x32_bf16 v[192:195], v[124:127], v[136:139], v[192:195]
    ds_read2_b32 v[66:67], v6 offset0:34 offset1:35
    v_mfma_f32_16x16x32_bf16 v[200:203], v[128:131], v[140:143], v[200:203]
    ds_read2_b32 v[68:69], v6 offset0:160 offset1:161
    v_mfma_f32_16x16x32_bf16 v[196:199], v[128:131], v[136:139], v[196:199]
    ds_read2_b32 v[70:71], v6 offset0:162 offset1:163
    v_mfma_f32_16x16x32_bf16 v[200:203], v[132:135], v[136:139], v[200:203]
    v_add_u32 v6, 128, v6
    s_cbranch_scc1 cv_51
    s_add_u32 s30, s31, 8912896
    s_lshl_b32 s28, s100, 2
    s_add_u32 s28, s28, 162628
    v_mov_b32 v4, s28
    v_mov_b32 v5, 0
    s_nop 2
    s_nop 0
    v_cvt_pk_bf16_f32 v104, v188, v189
    v_cvt_pk_bf16_f32 v105, v190, v191
    v_cvt_pk_bf16_f32 v106, v192, v193
    v_cvt_pk_bf16_f32 v107, v194, v195
    v_cvt_pk_bf16_f32 v108, v196, v197
    v_cvt_pk_bf16_f32 v109, v198, v199
    v_cvt_pk_bf16_f32 v110, v200, v201
    v_cvt_pk_bf16_f32 v111, v202, v203
    s_nop 1
    v_permlane16_swap_b32 v104, v106
    v_permlane16_swap_b32 v105, v107
    v_permlane16_swap_b32 v108, v110
    v_permlane16_swap_b32 v109, v111
    s_nop 1
    buffer_store_dwordx4 v[104:107], v7, s[20:23], s30 offen offset:2048 sc1
    buffer_store_dwordx4 v[108:111], v7, s[20:23], s30 offen offset:3072 sc1
    s_setprio 0
    s_waitcnt vmcnt(0)
    ds_write_b32 v4, v5
    s_mov_b32 s62, 0
lw_52:
    ds_read_b32 v5, v4 offset:12
    s_addk_i32 s62, 1
    s_waitcnt lgkmcnt(0)
    v_cmp_ne_u32 vcc, 0, v5
    s_cbranch_vccz lw_53
    s_sleep 2
    s_cmpk_lt_u32 s62, 0x7000
    s_cbranch_scc1 lw_52
lw_53:
k_fin:
    s_mul_i32 s26, s7, 2560
    s_lshr_b32 s25, s6, 2
    s_mul_i32 s25, s25, 20480
    s_add_u32 s26, s26, s25
    s_add_u32 s26, s26, 11587584
    v_and_b32 v3, 7, v0
    v_lshrrev_b32 v8, 3, v0
    v_lshlrev_b32_e64 v8, 12, v8
    v_lshl_add_u32 v8, v3, 4, v8
    s_mul_i32 s27, s7, 327680
    s_lshl_b32 s28, s6, 7
    s_add_u32 s27, s27, s28
    s_add_u32 s27, s27, 8912896
    v_bfe_u32 v2, v0, 2, 2
    v_lshlrev_b32 v2, 7, v2
    v_lshrrev_b32 v3, 4, v0
    v_lshl_add_u32 v2, v3, 5, v2
    v_and_b32_e64 v3, 3, v0
    v_lshl_add_u32 v2, v3, 3, v2
    v_add_u32 v2, s101, v2
    s_mul_i32 s28, s100, 48
    s_add_u32 s28, s28, s101
    v_lshlrev_b32 v3, 4, v0
    v_add_u32 v3, s28, v3
    v_lshlrev_b32 v7, 4, v0
    v_add_u32 v7, s101, v7
    s_waitcnt vmcnt(0)
    v_cmp_ne_u32 vcc, s61, v169
    s_cbranch_vccz ok_54
    s_mov_b32 s62, 0
pl_55:
    buffer_load_dwordx2 v[168:169], v170, s[20:23], s24 offen sc1
    s_addk_i32 s62, 1
    s_waitcnt vmcnt(0)
    v_cmp_ne_u32 vcc, s61, v169
    s_cbranch_vccz pl_56
    s_sleep 1
    s_cmpk_lt_u32 s62, 0x3000
    s_cbranch_scc1 pl_55
pl_56:
ok_54:
    v_cvt_pk_bf16_f32 v14, v168, 0
    v_lshlrev_b32 v15, 16, v14
    v_sub_f32 v12, 1.0, v15
    v_cvt_pk_bf16_f32 v12, v12, 0
    v_lshlrev_b32_e64 v13, 16, v12
    ds_write_b128 v7, v[12:15] offset:8704
    s_lshl_b32 s29, s100, 8
    s_add_u32 s12, s29, s26
    s_add_u32 s13, s12, 768
    s_add_u32 s14, s12, 1536
    s_add_u32 s15, s26, 2304
    s_cmp_eq_u32 s100, 0
    s_cselect_b32 s15, s15, s14
    s_mov_b32 s62, 0
yl_57:
    s_load_dwordx8 s[32:39], s[20:21], s12 glc
    s_load_dwordx8 s[40:47], s[20:21], s13 glc
    s_load_dwordx8 s[48:55], s[20:21], s14 glc
    s_load_dwordx4 s[8:11], s[20:21], s15 glc
    s_load_dwordx4 s[16:19], s[20:21], s15 offset:16 glc
    s_addk_i32 s62, 1
    s_waitcnt lgkmcnt(0)
    s_and_b64 s[28:29], s[32:33], s[34:35]
    s_or_b64 s[30:31], s[32:33], s[34:35]
    s_and_b64 s[28:29], s[28:29], s[36:37]
    s_or_b64 s[30:31], s[30:31], s[36:37]
    s_and_b64 s[28:29], s[28:29], s[38:39]
    s_or_b64 s[30:31], s[30:31], s[38:39]
    s_and_b64 s[28:29], s[28:29], s[40:41]
    s_or_b64 s[30:31], s[30:31], s[40:41]
    s_and_b64 s[28:29], s[28:29], s[42:43]
    s_or_b64 s[30:31], s[30:31], s[42:43]
    s_and_b64 s[28:29], s[28:29], s[44:45]
    s_or_b64 s[30:31], s[30:31], s[44:45]
    s_and_b64 s[28:29], s[28:29], s[46:47]
    s_or_b64 s[30:31], s[30:31], s[46:47]
    s_and_b64 s[28:29], s[28:29], s[48:49]
    s_or_b64 s[30:31], s[30:31], s[48:49]
    s_and_b64 s[28:29], s[28:29], s[50:51]
    s_or_b64 s[30:31], s[30:31], s[50:51]
    s_and_b64 s[28:29], s[28:29], s[52:53]
    s_or_b64 s[30:31], s[30:31], s[52:53]
    s_and_b64 s[28:29], s[28:29], s[54:55]
    s_or_b64 s[30:31], s[30:31], s[54:55]
    s_and_b64 s[28:29], s[28:29], s[8:9]
    s_or_b64 s[30:31], s[30:31], s[8:9]
    s_and_b64 s[28:29], s[28:29], s[10:11]
    s_or_b64 s[30:31], s[30:31], s[10:11]
    s_and_b64 s[28:29], s[28:29], s[16:17]
    s_or_b64 s[30:31], s[30:31], s[16:17]
    s_and_b64 s[28:29], s[28:29], s[18:19]
    s_or_b64 s[30:31], s[30:31], s[18:19]
    s_and_b32 s28, s28, s29
    s_or_b32 s30, s30, s31
    s_xor_b32 s28, s28, s61
    s_xor_b32 s30, s30, s61
    s_or_b32 s28, s28, s30
    s_cbranch_scc0 yl_58
    s_sleep 1
    s_cmpk_lt_u32 s62, 0x3000
    s_cbranch_scc1 yl_57
yl_58:
    s_add_u32 s28, s100, 0
    s_lshl_b32 s28, s28, 15
    s_add_u32 m0, s101, 0
    s_add_u32 s28, s28, s27
    buffer_load_dwordx4 v8, s[20:23], s28 offen sc1 lds
    s_add_u32 s28, s100, 3
    s_lshl_b32 s28, s28, 15
    s_add_u32 m0, s101, 1024
    s_add_u32 s28, s28, s27
    buffer_load_dwordx4 v8, s[20:23], s28 offen sc1 lds
    s_add_u32 s28, s100, 6
    s_lshl_b32 s28, s28, 15
    s_add_u32 m0, s101, 2048
    s_add_u32 s28, s28, s27
    buffer_load_dwordx4 v8, s[20:23], s28 offen sc1 lds
    s_add_u32 s28, s100, 9
    s_cmp_lg_u32 s100, 0
    s_cbranch_scc1 yl_58x
    s_lshl_b32 s28, s28, 15
    s_add_u32 m0, s101, 3072
    s_add_u32 s28, s28, s27
    buffer_load_dwordx4 v8, s[20:23], s28 offen sc1 lds
yl_58x:
    s_waitcnt vmcnt(0)
    ds_read_b64_tr_b16 v[8:9], v2 offset:0
    ds_read_b64_tr_b16 v[10:11], v2 offset:512
    ds_read_b64_tr_b16 v[12:13], v2 offset:1024
    ds_read_b64_tr_b16 v[14:15], v2 offset:1536
    ds_read_b64_tr_b16 v[16:17], v2 offset:2048
    ds_read_b64_tr_b16 v[18:19], v2 offset:2560
    ds_read_b64_tr_b16 v[20:21], v2 offset:3072
    ds_read_b64_tr_b16 v[22:23], v2 offset:3584
    s_waitcnt lgkmcnt(6)
    ds_write_b128 v3, v[8:11] offset:4096
    s_waitcnt lgkmcnt(5)
    ds_write_b128 v3, v[12:15] offset:5168
    s_waitcnt lgkmcnt(4)
    ds_write_b128 v3, v[16:19] offset:6240
    s_waitcnt lgkmcnt(3)
    ds_write_b128 v3, v[20:23] offset:7312
    s_branch k_post
k_l:
    v_lshrrev_b32 v8, 3, v0
    v_mul_u32_u24 v8, 1280, v8
    v_and_b32_e64 v10, 7, v0
    v_lshl_add_u32 v16, v10, 4, v8
    s_and_b32 s26, s2, 31
    s_lshr_b32 s27, s2, 5
    s_mul_i32 s28, s26, 81920
    s_lshl_b32 s27, s27, 7
    s_add_u32 s28, s28, s27
    s_mov_b32 s10, 2621440
    s_mov_b32 s11, 0x20000
    s_waitcnt lgkmcnt(0)
    s_mov_b32 s8, s32
    s_mov_b32 s9, s33
    s_barrier
    s_cmp_ge_u32 s2, 240
    s_cbranch_scc1 n1_59
    s_mov_b32 m0, 82048
    v_xor_b32 v17, 0, v16
    buffer_load_dwordx4 v17, s[8:11], s28 offen lds
    s_add_u32 s28, s28, 10240
    s_mov_b32 m0, 83072
    v_xor_b32_e64 v17, 16, v16
    buffer_load_dwordx4 v17, s[8:11], s28 offen lds
    s_add_u32 s28, s28, 10240
    s_mov_b32 m0, 84096
    v_xor_b32_e64 v17, 32, v16
    buffer_load_dwordx4 v17, s[8:11], s28 offen lds
    s_add_u32 s28, s28, 10240
    s_mov_b32 m0, 85120
    v_xor_b32_e64 v17, 48, v16
    buffer_load_dwordx4 v17, s[8:11], s28 offen lds
    s_add_u32 s28, s28, 10240
    s_mov_b32 m0, 86144
    v_xor_b32_e64 v17, 64, v16
    buffer_load_dwordx4 v17, s[8:11], s28 offen lds
    s_add_u32 s28, s28, 10240
    s_mov_b32 m0, 87168
    v_xor_b32 v17, 80, v16
    buffer_load_dwordx4 v17, s[8:11], s28 offen lds
    s_add_u32 s28, s28, 10240
    s_mov_b32 m0, 88192
    v_xor_b32 v17, 96, v16
    buffer_load_dwordx4 v17, s[8:11], s28 offen lds
    s_add_u32 s28, s28, 10240
    s_mov_b32 m0, 89216
    v_xor_b32 v17, 112, v16
    buffer_load_dwordx4 v17, s[8:11], s28 offen lds
    s_add_u32 s28, s28, 10240
n1_59:
    s_and_b32 s24, s97, 15
    s_mul_i32 s24, s24, 12288
    s_and_b32 s25, s96, 3
    s_lshl_b32 s25, s25, 1
    s_lshr_b32 s26, s96, 2
    s_add_u32 s25, s25, s26
    s_mul_i32 s25, s25, 384
    s_add_u32 s24, s24, s25
    v_min_u32 v18, 59, v0
    v_mul_u32_u24 v19, 43, v18
    v_lshrrev_b32_e64 v19, 9, v19
    v_mul_u32_u24 v9, 171, v18
    v_lshrrev_b32_e64 v9, 9, v9
    v_mul_u32_u24 v19, 184320, v19
    v_mul_u32_u24 v9, 2688, v9
    v_lshl_add_u32 v18, v18, 7, v19
    v_add3_u32 v18, v18, v9, s24
    s_cmp_ge_u32 s97, 16
    s_cmp_ge_u32 s97, 16
    s_cselect_b32 s24, s50, s48
    s_cselect_b32 s25, s51, s49
    global_load_dword v20, v18, s[24:25]
    s_cmp_ge_u32 s2, 240
    s_cbranch_scc1 n2_60
    s_mov_b32 s12, s52
    s_mov_b32 s13, s53
    s_mov_b32 s14, 1966080
    s_mov_b32 s15, 0x20000
    s_mul_i32 s27, s2, 2731
    s_lshr_b32 s27, s27, 16
    s_mul_i32 s26, s27, 24
    s_sub_u32 s26, s2, s26
    s_mul_i32 s45, s26, 81920
    s_lshl_b32 s27, s27, 7
    s_add_u32 s45, s45, s27
    s_sub_u32 s45, s45, 10240
    s_mov_b32 m0, 90240
    s_add_u32 s45, s45, 10240
    buffer_load_dwordx4 v16, s[12:15], s45 offen lds
    s_mov_b32 m0, 91264
    s_add_u32 s45, s45, 10240
    buffer_load_dwordx4 v16, s[12:15], s45 offen lds
    s_mov_b32 m0, 92288
    s_add_u32 s45, s45, 10240
    buffer_load_dwordx4 v16, s[12:15], s45 offen lds
    s_mov_b32 m0, 93312
    s_add_u32 s45, s45, 10240
    buffer_load_dwordx4 v16, s[12:15], s45 offen lds
    s_mov_b32 m0, 94336
    s_add_u32 s45, s45, 10240
    buffer_load_dwordx4 v16, s[12:15], s45 offen lds
    s_mov_b32 m0, 95360
    s_add_u32 s45, s45, 10240
    buffer_load_dwordx4 v16, s[12:15], s45 offen lds
    s_mov_b32 m0, 96384
    s_add_u32 s45, s45, 10240
    buffer_load_dwordx4 v16, s[12:15], s45 offen lds
    s_mov_b32 m0, 97408
    s_add_u32 s45, s45, 10240
    buffer_load_dwordx4 v16, s[12:15], s45 offen lds
    s_lshr_b32 s27, s97, 1
    s_lshl_b32 s27, s27, 3
    s_add_u32 s27, s27, s96
    s_add_u32 s27, s27, 240
    s_and_b32 s26, s97, 1
    s_cselect_b32 s27, s27, 999
    s_cmp_ge_u32 s27, 320
    s_cbranch_scc1 n2_60
    s_and_b32 s26, s27, 31
    s_lshr_b32 s27, s27, 5
    s_mul_i32 s28, s26, 81920
    s_lshl_b32 s27, s27, 7
    s_add_u32 s28, s28, s27
    s_mov_b32 m0, 98432
    v_xor_b32 v17, 0, v16
    buffer_load_dwordx4 v17, s[8:11], s28 offen lds
    s_add_u32 s28, s28, 10240
    s_mov_b32 m0, 99456
    v_xor_b32_e64 v17, 16, v16
    buffer_load_dwordx4 v17, s[8:11], s28 offen lds
    s_add_u32 s28, s28, 10240
    s_mov_b32 m0, 100480
    v_xor_b32_e64 v17, 32, v16
    buffer_load_dwordx4 v17, s[8:11], s28 offen lds
    s_add_u32 s28, s28, 10240
    s_mov_b32 m0, 101504
    v_xor_b32_e64 v17, 48, v16
    buffer_load_dwordx4 v17, s[8:11], s28 offen lds
    s_add_u32 s28, s28, 10240
    s_mov_b32 m0, 102528
    v_xor_b32_e64 v17, 64, v16
    buffer_load_dwordx4 v17, s[8:11], s28 offen lds
    s_add_u32 s28, s28, 10240
    s_mov_b32 m0, 103552
    v_xor_b32 v17, 80, v16
    buffer_load_dwordx4 v17, s[8:11], s28 offen lds
    s_add_u32 s28, s28, 10240
    s_mov_b32 m0, 104576
    v_xor_b32 v17, 96, v16
    buffer_load_dwordx4 v17, s[8:11], s28 offen lds
    s_add_u32 s28, s28, 10240
    s_mov_b32 m0, 105600
    v_xor_b32 v17, 112, v16
    buffer_load_dwordx4 v17, s[8:11], s28 offen lds
    s_add_u32 s28, s28, 10240
n2_60:
    v_lshlrev_b32_e64 v1, 4, v0
    v_mov_b32 v14, 0x7ffffff0
    s_mov_b32 s16, s54
    s_mov_b32 s17, s55
    s_mov_b32 s18, 1280
    s_mov_b32 s19, 0x20000
    s_mul_i32 s46, s2, 10240
    s_mov_b32 m0, 106624
    s_add_u32 s28, s46, 0
    s_nop 0
    buffer_load_dwordx4 v1, s[8:11], s28 offen offset:0 lds
    buffer_load_dwordx4 v1, s[8:11], s28 offen offset:1024 lds
    buffer_load_dwordx4 v1, s[8:11], s28 offen offset:2048 lds
    buffer_load_dwordx4 v1, s[8:11], s28 offen offset:3072 lds
    s_mov_b32 m0, 110720
    s_add_u32 s28, s46, 4096
    buffer_load_dwordx4 v1, s[8:11], s28 offen offset:0 lds
    buffer_load_dwordx4 v1, s[8:11], s28 offen offset:1024 lds
    buffer_load_dwordx4 v1, s[8:11], s28 offen offset:2048 lds
    buffer_load_dwordx4 v1, s[8:11], s28 offen offset:3072 lds
    s_mov_b32 m0, 114816
    s_add_u32 s28, s46, 8192
    buffer_load_dwordx4 v1, s[8:11], s28 offen offset:0 lds
    buffer_load_dwordx4 v1, s[8:11], s28 offen offset:1024 lds
    s_mov_b32 m0, 116864
    v_add_u32 v19, 983040, v18
    buffer_load_dwordx4 v1, s[16:19], 0 offen offset:0 lds
    buffer_load_dwordx4 v1, s[16:19], 0 offen offset:1024 lds
    s_mov_b32 m0, 162744
    s_nop 0
    buffer_load_dword v14, s[8:11], 0 offen lds
    global_load_dword v21, v19, s[24:25]
    s_mul_i32 s98, s97, 52
    s_lshr_b32 s98, s98, 8
    s_and_b32 s99, s96, 3
    s_lshr_b32 s6, s96, 2
    s_sub_u32 s4, s6, s98
    s_mul_i32 s4, s4, 5
    s_add_u32 s4, s4, s97
    s_mul_i32 s5, s99, 6
    s_add_u32 s5, s5, s98
    s_lshl_b32 s7, s99, 1
    s_add_u32 s7, s7, s6
    s_lshl_b32 s7, s7, 1
    s_add_u32 s7, s7, s97
    s_sub_u32 s7, s7, 30
    s_cmp_ge_u32 s2, 240
    s_cselect_b32 s4, 15, s4
    s_cselect_b32 s5, s7, s5
    s_lshr_b32 s6, s96, 1
    s_lshl_b32 s6, s6, 3
    s_and_b32 s7, s97, 7
    s_add_u32 s6, s6, s7
    s_and_b32 s7, s96, 1
    s_lshl_b32 s7, s7, 2
    s_lshr_b32 s22, s97, 3
    s_add_u32 s7, s7, s22
    s_mov_b32 s22, 0x2000000
    s_mov_b32 s23, 0x20000
    v_lshrrev_b32 v9, 4, v0
    v_xor_b32_e64 v9, v9, v10
    v_lshl_add_u32 v2, v9, 4, v8
    v_xor_b32_e64 v9, 4, v9
    v_lshl_add_u32 v3, v9, 4, v8
    v_add_u32 v3, 9216, v3
    v_add_u32 v4, 18432, v2
    v_add_u32 v5, 18432, v3
    v_mov_b32 v51, 0
    s_mov_b32 s29, 0
    s_mov_b32 s30, 0
    s_mov_b32 s31, 162740
    s_mov_b32 s12, s48
    s_mov_b32 s13, s49
    s_mov_b32 s14, 1966080
    s_mov_b32 s15, 0x20000
    s_mov_b32 s16, s50
    s_mov_b32 s17, s51
    s_mov_b32 s18, 1966080
    s_mov_b32 s19, 0x20000
    s_mov_b32 s36, 0x3fc
    s_cmp_ge_u32 s2, 240
    s_cbranch_scc1 k_ls
    v_lshrrev_b32_e64 v9, 3, v0
    v_mul_u32_u24 v9, 3072, v9
    v_bfe_u32 v22, v0, 4, 1
    v_and_b32 v10, 7, v0
    v_xor_b32 v22, v22, v10
    v_lshl_add_u32 v10, v22, 4, v9
    v_xor_b32_e64 v11, 64, v10
    v_add_u32 v11, 23552, v11
    v_add_u32 v12, 47104, v10
    v_add_u32 v13, 47104, v11
    s_mul_i32 s26, s4, 245760
    s_lshl_b32 s27, s5, 7
ld_61:
    s_add_u32 m0, s29, 24576
    s_add_u32 s28, s27, 0
    buffer_load_dwordx4 v10, s[12:15], s28 offen offset:0 lds
    s_add_u32 s33, s29, 41024
    buffer_load_dwordx4 v11, s[12:15], s28 offen offset:1024 lds
    s_cmp_eq_u32 s33, 123072
    s_cselect_b32 s33, 0, s33
    buffer_load_dwordx4 v12, s[12:15], s28 offen offset:2048 lds
    buffer_load_dwordx4 v13, s[12:15], s28 offen offset:3072 lds
    s_add_u32 m0, s29, 32832
    s_nop 0
    buffer_load_dwordx4 v10, s[16:19], s28 offen offset:0 lds
    s_add_u32 s30, s30, 1
    buffer_load_dwordx4 v11, s[16:19], s28 offen offset:1024 lds
    buffer_load_dwordx4 v12, s[16:19], s28 offen offset:2048 lds
    buffer_load_dwordx4 v13, s[16:19], s28 offen offset:3072 lds
    s_add_u32 m0, s29, 0
    s_add_u32 s28, s26, 0
    s_nop 0
    buffer_load_dwordx4 v2, s[8:11], s28 offen offset:0 lds
    buffer_load_dwordx4 v3, s[8:11], s28 offen offset:1024 lds
    buffer_load_dwordx4 v4, s[8:11], s28 offen offset:2048 lds
    buffer_load_dwordx4 v5, s[8:11], s28 offen offset:3072 lds
    s_add_u32 m0, s29, 4096
    s_add_u32 s28, s26, 40960
    buffer_load_dwordx4 v2, s[8:11], s28 offen offset:0 lds
    buffer_load_dwordx4 v3, s[8:11], s28 offen offset:1024 lds
    buffer_load_dwordx4 v4, s[8:11], s28 offen offset:2048 lds
    buffer_load_dwordx4 v5, s[8:11], s28 offen offset:3072 lds
    s_add_u32 m0, s29, 8192
    s_add_u32 s28, s26, 81920
    buffer_load_dwordx4 v2, s[8:11], s28 offen offset:0 lds
    buffer_load_dwordx4 v3, s[8:11], s28 offen offset:1024 lds
    buffer_load_dwordx4 v4, s[8:11], s28 offen offset:2048 lds
    buffer_load_dwordx4 v5, s[8:11], s28 offen offset:3072 lds
    s_add_u32 m0, s29, 12288
    s_add_u32 s28, s26, 122880
    buffer_load_dwordx4 v2, s[8:11], s28 offen offset:0 lds
    buffer_load_dwordx4 v3, s[8:11], s28 offen offset:1024 lds
    buffer_load_dwordx4 v4, s[8:11], s28 offen offset:2048 lds
    buffer_load_dwordx4 v5, s[8:11], s28 offen offset:3072 lds
    s_add_u32 m0, s29, 16384
    s_add_u32 s28, s26, 163840
    buffer_load_dwordx4 v2, s[8:11], s28 offen offset:0 lds
    buffer_load_dwordx4 v3, s[8:11], s28 offen offset:1024 lds
    buffer_load_dwordx4 v4, s[8:11], s28 offen offset:2048 lds
    buffer_load_dwordx4 v5, s[8:11], s28 offen offset:3072 lds
    s_add_u32 m0, s29, 20480
    s_add_u32 s28, s26, 204800
    buffer_load_dwordx4 v2, s[8:11], s28 offen offset:0 lds
    buffer_load_dwordx4 v3, s[8:11], s28 offen offset:1024 lds
    s_add_u32 s26, s26, 128
    buffer_load_dwordx4 v4, s[8:11], s28 offen offset:2048 lds
    buffer_load_dwordx4 v5, s[8:11], s28 offen offset:3072 lds
    s_mov_b32 m0, s31
    s_sub_u32 s31, s31, 4
    buffer_load_dword v14, s[8:11], 0 offen lds
    s_add_u32 m0, s29, 28672
    s_add_u32 s28, s27, 98304
    buffer_load_dwordx4 v10, s[12:15], s28 offen offset:0 lds
    buffer_load_dwordx4 v11, s[12:15], s28 offen offset:1024 lds
    s_add_u32 s27, s27, 196608
    buffer_load_dwordx4 v12, s[12:15], s28 offen offset:2048 lds
    buffer_load_dwordx4 v13, s[12:15], s28 offen offset:3072 lds
    s_add_u32 m0, s29, 36928
    s_nop 0
    buffer_load_dwordx4 v10, s[16:19], s28 offen offset:0 lds
    buffer_load_dwordx4 v11, s[16:19], s28 offen offset:1024 lds
    buffer_load_dwordx4 v12, s[16:19], s28 offen offset:2048 lds
    s_mov_b32 s29, s33
    buffer_load_dwordx4 v13, s[16:19], s28 offen offset:3072 lds
    s_mov_b32 m0, s31
    s_sub_u32 s31, s31, 4
    buffer_load_dword v14, s[8:11], 0 offen lds
    s_bitcmp0_b32 s36, s30
    s_cbranch_scc1 sk_62
    s_waitcnt vmcnt(42)
    s_barrier
sk_62:
    s_cmp_lt_u32 s30, 10
    s_cbranch_scc1 ld_61
k_lj:
    s_load_dword s61, s[58:59], 0
    s_mov_b32 s62, 0
    s_waitcnt lgkmcnt(0)
tg_63:
    s_cmp_lg_u32 s61, 0
    s_cbranch_scc1 tg_64
    v_mov_b32_e64 v2, 0
    global_load_dword v2, v2, s[58:59] sc1
    s_addk_i32 s62, 1
    s_waitcnt vmcnt(0)
    v_readfirstlane_b32 s61, v2
    s_sleep 1
    s_cmpk_lt_u32 s62, 0x3000
    s_cbranch_scc1 tg_63
tg_64:
    v_and_b32 v17, 15, v0
    v_lshrrev_b32 v18, 4, v0
    s_mov_b32 s101, 123072
    v_mov_b32 v170, 0
    v_lshlrev_b32 v2, 4, v18
    v_lshlrev_b32 v6, 5, v17
    v_sub_u32 v2, v2, v6
    v_add_u32 v2, 8928, v2
    v_add_u32 v2, s101, v2
    v_sub_u32 v6, 15, v17
    v_and_b32 v7, 1, v6
    v_sub_u32 v6, v6, v7
    v_mul_u32_u24 v3, 4160, v7
    v_lshl_add_u32 v3, v18, 4, v3
    v_lshlrev_b32 v6, 1, v6
    v_sub_u32 v3, v3, v6
    v_add_u32 v3, 64, v3
    v_add_u32 v3, s101, v3
    v_add_u32 v4, 1024, v3
    v_add_u32 v5, 2048, v3
    v_add_u32 v6, 3072, v3
    v_lshlrev_b32 v7, 5, v17
    v_lshrrev_b32 v8, 1, v18
    v_lshl_add_u32 v7, v8, 4, v7
    v_and_b32_e64 v8, 1, v18
    v_lshl_add_u32 v7, v8, 9, v7
    s_lshr_b32 s10, s97, 1
    s_lshl_b32 s10, s10, 3
    s_add_u32 s10, s10, s96
    s_mul_i32 s10, s10, 5
    s_and_b32 s8, s97, 1
    s_cselect_b32 s9, 1, 3
    s_mul_i32 s8, s8, 3
    s_add_u32 s10, s10, s8
    s_mov_b32 s8, 0
k_cl:
    s_lshl_b32 s30, s10, 12
    s_add_u32 s30, s30, 8912896
    s_mov_b32 s11, s9
    s_barrier
    s_setprio 1
    s_nop 0
    ds_read2_b32 v[40:41], v3 offset0:0 offset1:1
    ds_read2_b32 v[42:43], v3 offset0:2 offset1:3
    ds_read_b128 v[84:87], v2 offset:2048
    ds_read_b128 v[80:83], v2 offset:2560
    ds_read_b128 v[76:79], v2 offset:3072
    ds_read_b128 v[72:75], v2 offset:3584
    ds_read2_b32 v[44:45], v3 offset0:128 offset1:129
    ds_read2_b32 v[46:47], v3 offset0:130 offset1:131
    ds_read2_b32 v[48:49], v4 offset0:0 offset1:1
    ds_read2_b32 v[50:51], v4 offset0:2 offset1:3
    ds_read2_b32 v[52:53], v4 offset0:128 offset1:129
    ds_read2_b32 v[54:55], v4 offset0:130 offset1:131
cl_65:
    s_nop 0
    s_waitcnt lgkmcnt(6)
    v_mfma_f32_16x16x32_bf16 v[184:187], v[40:43], v[84:87], 0
    ds_read2_b32 v[104:105], v3 offset0:16 offset1:17
    ds_read2_b32 v[106:107], v3 offset0:18 offset1:19
    v_mfma_f32_16x16x32_bf16 v[180:183], v[40:43], v[80:83], 0
    ds_read_b128 v[148:151], v2 offset:2112
    v_mfma_f32_16x16x32_bf16 v[176:179], v[40:43], v[76:79], 0
    ds_read_b128 v[144:147], v2 offset:2624
    v_mfma_f32_16x16x32_bf16 v[172:175], v[40:43], v[72:75], 0
    ds_read_b128 v[140:143], v2 offset:3136
    s_waitcnt lgkmcnt(9)
    v_mfma_f32_16x16x32_bf16 v[184:187], v[44:47], v[80:83], v[184:187]
    ds_read_b128 v[136:139], v2 offset:3648
    v_mfma_f32_16x16x32_bf16 v[180:183], v[44:47], v[76:79], v[180:183]
    ds_read2_b32 v[108:109], v3 offset0:144 offset1:145
    ds_read2_b32 v[110:111], v3 offset0:146 offset1:147
    v_mfma_f32_16x16x32_bf16 v[176:179], v[44:47], v[72:75], v[176:179]
    ds_read2_b32 v[112:113], v4 offset0:16 offset1:17
    s_waitcnt lgkmcnt(11)
    v_mfma_f32_16x16x32_bf16 v[184:187], v[48:51], v[76:79], v[184:187]
    ds_read2_b32 v[114:115], v4 offset0:18 offset1:19
    v_mfma_f32_16x16x32_bf16 v[180:183], v[48:51], v[72:75], v[180:183]
    ds_read2_b32 v[116:117], v4 offset0:144 offset1:145
    s_waitcnt lgkmcnt(11)
    v_mfma_f32_16x16x32_bf16 v[184:187], v[52:55], v[72:75], v[184:187]
    ds_read2_b32 v[118:119], v4 offset0:146 offset1:147
    s_waitcnt lgkmcnt(6)
    v_mfma_f32_16x16x32_bf16 v[184:187], v[104:107], v[148:151], v[184:187]
    ds_read2_b32 v[40:41], v3 offset0:32 offset1:33
    ds_read2_b32 v[42:43], v3 offset0:34 offset1:35
    v_mfma_f32_16x16x32_bf16 v[180:183], v[104:107], v[144:147], v[180:183]
    ds_read_b128 v[84:87], v2 offset:2176
    v_mfma_f32_16x16x32_bf16 v[176:179], v[104:107], v[140:143], v[176:179]
    ds_read_b128 v[80:83], v2 offset:2688
    v_mfma_f32_16x16x32_bf16 v[172:175], v[104:107], v[136:139], v[172:175]
    ds_read_b128 v[76:79], v2 offset:3200
    s_waitcnt lgkmcnt(9)
    v_mfma_f32_16x16x32_bf16 v[184:187], v[108:111], v[144:147], v[184:187]
    ds_read_b128 v[72:75], v2 offset:3712
    v_mfma_f32_16x16x32_bf16 v[180:183], v[108:111], v[140:143], v[180:183]
    ds_read2_b32 v[44:45], v3 offset0:160 offset1:161
    ds_read2_b32 v[46:47], v3 offset0:162 offset1:163
    v_mfma_f32_16x16x32_bf16 v[176:179], v[108:111], v[136:139], v[176:179]
    ds_read2_b32 v[48:49], v4 offset0:32 offset1:33
    s_waitcnt lgkmcnt(11)
    v_mfma_f32_16x16x32_bf16 v[184:187], v[112:115], v[140:143], v[184:187]
    ds_read2_b32 v[50:51], v4 offset0:34 offset1:35
    v_mfma_f32_16x16x32_bf16 v[180:183], v[112:115], v[136:139], v[180:183]
    ds_read2_b32 v[52:53], v4 offset0:160 offset1:161
    s_waitcnt lgkmcnt(11)
    v_mfma_f32_16x16x32_bf16 v[184:187], v[116:119], v[136:139], v[184:187]
    ds_read2_b32 v[54:55], v4 offset0:162 offset1:163
    s_waitcnt lgkmcnt(6)
    v_mfma_f32_16x16x32_bf16 v[184:187], v[40:43], v[84:87], v[184:187]
    ds_read2_b32 v[104:105], v3 offset0:48 offset1:49
    ds_read2_b32 v[106:107], v3 offset0:50 offset1:51
    v_mfma_f32_16x16x32_bf16 v[180:183], v[40:43], v[80:83], v[180:183]
    ds_read_b128 v[148:151], v2 offset:2240
    v_mfma_f32_16x16x32_bf16 v[176:179], v[40:43], v[76:79], v[176:179]
    ds_read_b128 v[144:147], v2 offset:2752
    v_mfma_f32_16x16x32_bf16 v[172:175], v[40:43], v[72:75], v[172:175]
    ds_read_b128 v[140:143], v2 offset:3264
    s_waitcnt lgkmcnt(9)
    v_mfma_f32_16x16x32_bf16 v[184:187], v[44:47], v[80:83], v[184:187]
    ds_read_b128 v[136:139], v2 offset:3776
    v_mfma_f32_16x16x32_bf16 v[180:183], v[44:47], v[76:79], v[180:183]
    ds_read2_b32 v[108:109], v3 offset0:176 offset1:177
    ds_read2_b32 v[110:111], v3 offset0:178 offset1:179
    v_mfma_f32_16x16x32_bf16 v[176:179], v[44:47], v[72:75], v[176:179]
    ds_read2_b32 v[112:113], v4 offset0:48 offset1:49
    s_waitcnt lgkmcnt(11)
    v_mfma_f32_16x16x32_bf16 v[184:187], v[48:51], v[76:79], v[184:187]
    ds_read2_b32 v[114:115], v4 offset0:50 offset1:51
    v_mfma_f32_16x16x32_bf16 v[180:183], v[48:51], v[72:75], v[180:183]
    ds_read2_b32 v[116:117], v4 offset0:176 offset1:177
    s_waitcnt lgkmcnt(11)
    v_mfma_f32_16x16x32_bf16 v[184:187], v[52:55], v[72:75], v[184:187]
    ds_read2_b32 v[118:119], v4 offset0:178 offset1:179
    s_waitcnt lgkmcnt(6)
    v_mfma_f32_16x16x32_bf16 v[184:187], v[104:107], v[148:151], v[184:187]
    ds_read2_b32 v[40:41], v3 offset0:64 offset1:65
    ds_read2_b32 v[42:43], v3 offset0:66 offset1:67
    v_mfma_f32_16x16x32_bf16 v[180:183], v[104:107], v[144:147], v[180:183]
    ds_read_b128 v[84:87], v2 offset:2304
    v_mfma_f32_16x16x32_bf16 v[176:179], v[104:107], v[140:143], v[176:179]
    ds_read_b128 v[80:83], v2 offset:2816
    v_mfma_f32_16x16x32_bf16 v[172:175], v[104:107], v[136:139], v[172:175]
    ds_read_b128 v[76:79], v2 offset:3328
    s_waitcnt lgkmcnt(9)
    v_mfma_f32_16x16x32_bf16 v[184:187], v[108:111], v[144:147], v[184:187]
    ds_read_b128 v[72:75], v2 offset:3840
    v_mfma_f32_16x16x32_bf16 v[180:183], v[108:111], v[140:143], v[180:183]
    ds_read2_b32 v[44:45], v3 offset0:192 offset1:193
    ds_read2_b32 v[46:47], v3 offset0:194 offset1:195
    v_mfma_f32_16x16x32_bf16 v[176:179], v[108:111], v[136:139], v[176:179]
    ds_read2_b32 v[48:49], v4 offset0:64 offset1:65
    s_waitcnt lgkmcnt(11)
    v_mfma_f32_16x16x32_bf16 v[184:187], v[112:115], v[140:143], v[184:187]
    ds_read2_b32 v[50:51], v4 offset0:66 offset1:67
    v_mfma_f32_16x16x32_bf16 v[180:183], v[112:115], v[136:139], v[180:183]
    ds_read2_b32 v[52:53], v4 offset0:192 offset1:193
    s_waitcnt lgkmcnt(11)
    v_mfma_f32_16x16x32_bf16 v[184:187], v[116:119], v[136:139], v[184:187]
    ds_read2_b32 v[54:55], v4 offset0:194 offset1:195
    s_waitcnt lgkmcnt(6)
    v_mfma_f32_16x16x32_bf16 v[184:187], v[40:43], v[84:87], v[184:187]
    ds_read2_b32 v[104:105], v3 offset0:80 offset1:81
    ds_read2_b32 v[106:107], v3 offset0:82 offset1:83
    v_mfma_f32_16x16x32_bf16 v[180:183], v[40:43], v[80:83], v[180:183]
    ds_read_b128 v[148:151], v2 offset:2368
    v_mfma_f32_16x16x32_bf16 v[176:179], v[40:43], v[76:79], v[176:179]
    ds_read_b128 v[144:147], v2 offset:2880
    v_mfma_f32_16x16x32_bf16 v[172:175], v[40:43], v[72:75], v[172:175]
    ds_read_b128 v[140:143], v2 offset:3392
    s_waitcnt lgkmcnt(9)
    v_mfma_f32_16x16x32_bf16 v[184:187], v[44:47], v[80:83], v[184:187]
    ds_read_b128 v[136:139], v2 offset:3904
    v_mfma_f32_16x16x32_bf16 v[180:183], v[44:47], v[76:79], v[180:183]
    ds_read2_b32 v[108:109], v3 offset0:208 offset1:209
    ds_read2_b32 v[110:111], v3 offset0:210 offset1:211
    v_mfma_f32_16x16x32_bf16 v[176:179], v[44:47], v[72:75], v[176:179]
    ds_read2_b32 v[112:113], v4 offset0:80 offset1:81
    s_waitcnt lgkmcnt(11)
    v_mfma_f32_16x16x32_bf16 v[184:187], v[48:51], v[76:79], v[184:187]
    ds_read2_b32 v[114:115], v4 offset0:82 offset1:83
    v_mfma_f32_16x16x32_bf16 v[180:183], v[48:51], v[72:75], v[180:183]
    ds_read2_b32 v[116:117], v4 offset0:208 offset1:209
    s_waitcnt lgkmcnt(11)
    v_mfma_f32_16x16x32_bf16 v[184:187], v[52:55], v[72:75], v[184:187]
    ds_read2_b32 v[118:119], v4 offset0:210 offset1:211
    s_waitcnt lgkmcnt(6)
    v_mfma_f32_16x16x32_bf16 v[184:187], v[104:107], v[148:151], v[184:187]
    ds_read2_b32 v[40:41], v3 offset0:96 offset1:97
    ds_read2_b32 v[42:43], v3 offset0:98 offset1:99
    v_mfma_f32_16x16x32_bf16 v[180:183], v[104:107], v[144:147], v[180:183]
    ds_read_b128 v[84:87], v2 offset:2432
    v_mfma_f32_16x16x32_bf16 v[176:179], v[104:107], v[140:143], v[176:179]
    ds_read_b128 v[80:83], v2 offset:2944
    v_mfma_f32_16x16x32_bf16 v[172:175], v[104:107], v[136:139], v[172:175]
    ds_read_b128 v[76:79], v2 offset:3456
    s_waitcnt lgkmcnt(9)
    v_mfma_f32_16x16x32_bf16 v[184:187], v[108:111], v[144:147], v[184:187]
    ds_read_b128 v[72:75], v2 offset:3968
    v_mfma_f32_16x16x32_bf16 v[180:183], v[108:111], v[140:143], v[180:183]
    ds_read2_b32 v[44:45], v3 offset0:224 offset1:225
    ds_read2_b32 v[46:47], v3 offset0:226 offset1:227
    v_mfma_f32_16x16x32_bf16 v[176:179], v[108:111], v[136:139], v[176:179]
    ds_read2_b32 v[48:49], v4 offset0:96 offset1:97
    s_waitcnt lgkmcnt(11)
    v_mfma_f32_16x16x32_bf16 v[184:187], v[112:115], v[140:143], v[184:187]
    ds_read2_b32 v[50:51], v4 offset0:98 offset1:99
    v_mfma_f32_16x16x32_bf16 v[180:183], v[112:115], v[136:139], v[180:183]
    ds_read2_b32 v[52:53], v4 offset0:224 offset1:225
    s_waitcnt lgkmcnt(11)
    v_mfma_f32_16x16x32_bf16 v[184:187], v[116:119], v[136:139], v[184:187]
    ds_read2_b32 v[54:55], v4 offset0:226 offset1:227
    s_waitcnt lgkmcnt(6)
    v_mfma_f32_16x16x32_bf16 v[184:187], v[40:43], v[84:87], v[184:187]
    ds_read2_b32 v[104:105], v3 offset0:112 offset1:113
    ds_read2_b32 v[106:107], v3 offset0:114 offset1:115
    v_mfma_f32_16x16x32_bf16 v[180:183], v[40:43], v[80:83], v[180:183]
    ds_read_b128 v[148:151], v2 offset:2496
    v_mfma_f32_16x16x32_bf16 v[176:179], v[40:43], v[76:79], v[176:179]
    ds_read_b128 v[144:147], v2 offset:3008
    v_mfma_f32_16x16x32_bf16 v[172:175], v[40:43], v[72:75], v[172:175]
    ds_read_b128 v[140:143], v2 offset:3520
    s_waitcnt lgkmcnt(9)
    v_mfma_f32_16x16x32_bf16 v[184:187], v[44:47], v[80:83], v[184:187]
    ds_read_b128 v[136:139], v2 offset:4032
    v_mfma_f32_16x16x32_bf16 v[180:183], v[44:47], v[76:79], v[180:183]
    ds_read2_b32 v[108:109], v3 offset0:240 offset1:241
    ds_read2_b32 v[110:111], v3 offset0:242 offset1:243
    v_mfma_f32_16x16x32_bf16 v[176:179], v[44:47], v[72:75], v[176:179]
    ds_read2_b32 v[112:113], v4 offset0:112 offset1:113
    s_waitcnt lgkmcnt(11)
    v_mfma_f32_16x16x32_bf16 v[184:187], v[48:51], v[76:79], v[184:187]
    ds_read2_b32 v[114:115], v4 offset0:114 offset1:115
    v_mfma_f32_16x16x32_bf16 v[180:183], v[48:51], v[72:75], v[180:183]
    ds_read2_b32 v[116:117], v4 offset0:240 offset1:241
    s_waitcnt lgkmcnt(11)
    v_mfma_f32_16x16x32_bf16 v[184:187], v[52:55], v[72:75], v[184:187]
    ds_read2_b32 v[118:119], v4 offset0:242 offset1:243
    s_waitcnt lgkmcnt(6)
    v_mfma_f32_16x16x32_bf16 v[184:187], v[104:107], v[148:151], v[184:187]
    v_add_u32 v3, 13184, v3
    v_add_u32 v2, 13184, v2
    v_mfma_f32_16x16x32_bf16 v[180:183], v[104:107], v[144:147], v[180:183]
    v_add_u32 v4, 13184, v4
    v_mfma_f32_16x16x32_bf16 v[176:179], v[104:107], v[140:143], v[176:179]
    ds_read2_b32 v[40:41], v3 offset0:0 offset1:1
    ds_read2_b32 v[42:43], v3 offset0:2 offset1:3
    v_mfma_f32_16x16x32_bf16 v[172:175], v[104:107], v[136:139], v[172:175]
    ds_read_b128 v[84:87], v2 offset:2048
    s_nop 0
    s_waitcnt lgkmcnt(7)
    v_mfma_f32_16x16x32_bf16 v[184:187], v[108:111], v[144:147], v[184:187]
    ds_read_b128 v[80:83], v2 offset:2560
    ds_read_b128 v[76:79], v2 offset:3072
    v_mfma_f32_16x16x32_bf16 v[180:183], v[108:111], v[140:143], v[180:183]
    ds_read_b128 v[72:75], v2 offset:3584
    v_mfma_f32_16x16x32_bf16 v[176:179], v[108:111], v[136:139], v[176:179]
    ds_read2_b32 v[44:45], v3 offset0:128 offset1:129
    ds_read2_b32 v[46:47], v3 offset0:130 offset1:131
    s_waitcnt lgkmcnt(10)
    v_mfma_f32_16x16x32_bf16 v[184:187], v[112:115], v[140:143], v[184:187]
    ds_read2_b32 v[48:49], v4 offset0:0 offset1:1
    v_mfma_f32_16x16x32_bf16 v[180:183], v[112:115], v[136:139], v[180:183]
    ds_read2_b32 v[50:51], v4 offset0:2 offset1:3
    ds_read2_b32 v[52:53], v4 offset0:128 offset1:129
    s_waitcnt lgkmcnt(11)
    v_mfma_f32_16x16x32_bf16 v[184:187], v[116:119], v[136:139], v[184:187]
    ds_read2_b32 v[54:55], v4 offset0:130 offset1:131
    s_sub_u32 s11, s11, 1
    s_nop 6
    v_cvt_pk_bf16_f32 v8, v172, v173
    v_cvt_pk_bf16_f32 v9, v174, v175
    v_cvt_pk_bf16_f32 v10, v176, v177
    v_cvt_pk_bf16_f32 v11, v178, v179
    v_cvt_pk_bf16_f32 v12, v180, v181
    v_cvt_pk_bf16_f32 v13, v182, v183
    v_cvt_pk_bf16_f32 v14, v184, v185
    v_cvt_pk_bf16_f32 v15, v186, v187
    s_nop 1
    v_permlane16_swap_b32 v8, v10
    v_permlane16_swap_b32 v9, v11
    v_permlane16_swap_b32 v12, v14
    v_permlane16_swap_b32 v13, v15
    s_nop 1
    buffer_store_dwordx4 v[8:11], v7, s[20:23], s30 offen offset:0 sc1
    buffer_store_dwordx4 v[12:15], v7, s[20:23], s30 offen offset:1024 sc1
    s_add_u32 s30, s30, 4096
    s_cmp_lg_u32 s11, 0
    s_cbranch_scc1 cl_65
    s_setprio 0
    v_lshrrev_b32 v20, 3, v0
    s_sub_u32 s11, s9, 1
    v_min_u32 v20, s11, v20
    v_add_u32 v21, s8, v20
    v_lshlrev_b32 v21, 2, v21
    v_add_u32 v21, 162628, v21
    v_mov_b32_e64 v22, 0
    ds_write_b32 v21, v22 offset:12
    v_add_u32 v20, s10, v20
    v_lshrrev_b32 v23, 3, v20
    v_lshlrev_b32 v23, 8, v23
    v_and_b32 v20, 7, v20
    v_lshl_add_u32 v23, v20, 2, v23
    v_and_b32_e64 v20, 7, v0
    v_mul_u32_u24 v20, 20480, v20
    v_add_u32 v23, v23, v20
    v_mov_b32 v20, s61
    s_mov_b32 s28, 11587584
    s_lshl_b32 s11, s9, 3
    s_mov_b32 s62, 0
lw_66:
    ds_read_b32 v22, v21 offset:0
    s_addk_i32 s62, 1
    s_waitcnt lgkmcnt(0)
    v_cmp_ne_u32 vcc, 0, v22
    s_cbranch_vccz lw_67
    s_sleep 1
    s_cmpk_lt_u32 s62, 0x7000
    s_cbranch_scc1 lw_66
lw_67:
    s_bfm_b64 exec, s11, 0
    s_waitcnt vmcnt(0)
    buffer_store_dword v20, v23, s[20:23], s28 offen sc1
    s_mov_b64 exec, -1
    s_cmp_eq_u32 s3, 4
    s_cbranch_scc1 k_post
    s_branch k_fin
    s_branch k_post
k_ss:
    v_and_b32 v8, 31, v0
    v_lshrrev_b32 v9, 5, v0
    v_bfe_u32 v10, v0, 1, 3
    v_xor_b32 v10, v10, v9
    s_lshl_b32 s10, s8, 13
    v_lshlrev_b32 v14, 7, v8
    v_add_u32 v14, s10, v14
    v_xor_b32_e64 v12, 0, v10
    v_lshl_add_u32 v2, v12, 4, v14
    v_xor_b32_e64 v12, 2, v10
    v_lshl_add_u32 v3, v12, 4, v14
    v_xor_b32_e64 v12, 4, v10
    v_lshl_add_u32 v4, v12, 4, v14
    v_xor_b32_e64 v12, 6, v10
    v_lshl_add_u32 v5, v12, 4, v14
    v_and_b32 v10, 15, v0
    v_lshlrev_b32 v10, 4, v10
    v_lshl_add_u32 v10, v9, 8, v10
    v_bfe_u32 v13, v0, 4, 1
    v_lshl_add_u32 v10, v13, 10, v10
    v_bfe_u32 v12, v0, 2, 2
    v_lshl_add_u32 v12, v9, 3, v12
    v_and_b32 v14, 3, v0
    v_lshlrev_b32 v14, 3, v14
    v_mul_u32_u24 v6, 192, v12
    v_add_u32_e64 v6, v6, v14
    v_mul_u32_u24 v13, 12320, v13
    s_mul_i32 s10, s9, 96
    s_add_u32 s10, s10, 16384
    v_add3_u32 v6, v6, v13, s10
    v_add_u32 v9, 2048, v10
    s_add_u32 s18, s8, 30
    s_mul_i32 s11, s18, 196608
    s_mul_i32 s12, s5, 6
    s_mul_i32 s13, s9, 3
    s_add_u32 s12, s12, s13
    s_add_u32 s13, s12, 0
    s_lshr_b32 s10, s13, 1
    s_lshl_b32 s10, s10, 12
    s_and_b32 s13, s13, 1
    s_lshl_b32 s13, s13, 9
    s_add_u32 s10, s10, s13
    s_add_u32 s48, s10, s11
    s_add_u32 s13, s12, 1
    s_lshr_b32 s10, s13, 1
    s_lshl_b32 s10, s10, 12
    s_and_b32 s13, s13, 1
    s_lshl_b32 s13, s13, 9
    s_add_u32 s10, s10, s13
    s_add_u32 s49, s10, s11
    s_add_u32 s13, s12, 2
    s_lshr_b32 s10, s13, 1
    s_lshl_b32 s10, s10, 12
    s_and_b32 s13, s13, 1
    s_lshl_b32 s13, s13, 9
    s_add_u32 s10, s10, s13
    s_add_u32 s50, s10, s11
    s_lshl_b32 s51, s18, 2
    s_lshr_b32 s10, s5, 2
    s_add_u32 s51, s51, s10
    s_lshl_b32 s51, s51, 8
    s_and_b32 s10, s5, 3
    s_lshl_b32 s10, s10, 1
    s_add_u32 s10, s10, s9
    s_mul_i32 s10, s10, 12
    s_add_u32 s51, s51, s10
    s_add_u32 s51, s51, 11550720
    s_mov_b32 s46, 0
    s_mov_b32 s47, 8
    s_branch k_nosetup
k_ms:
    s_barrier
    ds_read_b128 v[16:19], v2
    ds_read_b64_tr_b16 v[24:25], v6 offset:0
    ds_read_b64_tr_b16 v[26:27], v6 offset:768
    ds_read_b64_tr_b16 v[28:29], v6 offset:32
    ds_read_b64_tr_b16 v[30:31], v6 offset:800
    ds_read_b64_tr_b16 v[32:33], v6 offset:64
    ds_read_b64_tr_b16 v[34:35], v6 offset:832
    ds_read_b128 v[20:23], v2 offset:4096
    ds_read_b128 v[36:39], v3
    ds_read_b64_tr_b16 v[44:45], v6 offset:3072
    ds_read_b64_tr_b16 v[46:47], v6 offset:3840
    ds_read_b64_tr_b16 v[48:49], v6 offset:3104
    ds_read_b64_tr_b16 v[50:51], v6 offset:3872
    s_waitcnt lgkmcnt(10)
    v_mfma_f32_32x32x16_bf16 v[64:79], v[24:27], v[16:19], 0
    ds_read_b64_tr_b16 v[52:53], v6 offset:3136
    ds_read_b64_tr_b16 v[54:55], v6 offset:3904
    s_waitcnt lgkmcnt(10)
    v_mfma_f32_32x32x16_bf16 v[80:95], v[28:31], v[16:19], 0
    ds_read_b128 v[40:43], v3 offset:4096
    s_add_u32 s12, s12, 1
    s_cmp_eq_u32 s12, 3
    s_waitcnt lgkmcnt(9)
    v_mfma_f32_32x32x16_bf16 v[96:111], v[32:35], v[16:19], 0
    ds_read_b128 v[16:19], v4
    s_cselect_b32 s13, s16, s17
    s_cselect_b32 s12, 0, s12
    s_waitcnt lgkmcnt(9)
    v_mfma_f32_32x32x16_bf16 v[112:127], v[24:27], v[20:23], 0
    ds_read_b64_tr_b16 v[24:25], v6 offset:6144
    v_mfma_f32_32x32x16_bf16 v[128:143], v[28:31], v[20:23], 0
    ds_read_b64_tr_b16 v[26:27], v6 offset:6912
    ds_read_b64_tr_b16 v[28:29], v6 offset:6176
    v_mfma_f32_32x32x16_bf16 v[144:159], v[32:35], v[20:23], 0
    ds_read_b64_tr_b16 v[30:31], v6 offset:6944
    v_add_u32 v3, s13, v3
    s_branch g1e_69
g1_68:
    s_waitcnt lgkmcnt(10)
    v_mfma_f32_32x32x16_bf16 v[64:79], v[24:27], v[16:19], v[64:79]
    ds_read_b64_tr_b16 v[52:53], v6 offset:3136
    ds_read_b64_tr_b16 v[54:55], v6 offset:3904
    s_waitcnt lgkmcnt(10)
    v_mfma_f32_32x32x16_bf16 v[80:95], v[28:31], v[16:19], v[80:95]
    ds_read_b128 v[40:43], v3 offset:4096
    s_add_u32 s12, s12, 1
    s_cmp_eq_u32 s12, 3
    s_waitcnt lgkmcnt(9)
    v_mfma_f32_32x32x16_bf16 v[96:111], v[32:35], v[16:19], v[96:111]
    ds_read_b128 v[16:19], v4
    s_cselect_b32 s13, s16, s17
    s_cselect_b32 s12, 0, s12
    s_waitcnt lgkmcnt(9)
    v_mfma_f32_32x32x16_bf16 v[112:127], v[24:27], v[20:23], v[112:127]
    ds_read_b64_tr_b16 v[24:25], v6 offset:6144
    v_mfma_f32_32x32x16_bf16 v[128:143], v[28:31], v[20:23], v[128:143]
    ds_read_b64_tr_b16 v[26:27], v6 offset:6912
    ds_read_b64_tr_b16 v[28:29], v6 offset:6176
    v_mfma_f32_32x32x16_bf16 v[144:159], v[32:35], v[20:23], v[144:159]
    ds_read_b64_tr_b16 v[30:31], v6 offset:6944
    v_add_u32 v3, s13, v3
g1e_69:
    s_waitcnt lgkmcnt(10)
    v_mfma_f32_32x32x16_bf16 v[64:79], v[44:47], v[36:39], v[64:79]
    ds_read_b64_tr_b16 v[32:33], v6 offset:6208
    ds_read_b64_tr_b16 v[34:35], v6 offset:6976
    s_waitcnt lgkmcnt(10)
    v_mfma_f32_32x32x16_bf16 v[80:95], v[48:51], v[36:39], v[80:95]
    ds_read_b128 v[20:23], v4 offset:4096
    v_add_u32 v2, s13, v2
    s_waitcnt lgkmcnt(9)
    v_mfma_f32_32x32x16_bf16 v[96:111], v[52:55], v[36:39], v[96:111]
    ds_read_b128 v[36:39], v5
    s_add_u32 s11, s11, 1
    s_waitcnt lgkmcnt(9)
    v_mfma_f32_32x32x16_bf16 v[112:127], v[44:47], v[40:43], v[112:127]
    ds_read_b64_tr_b16 v[44:45], v6 offset:9216
    v_mfma_f32_32x32x16_bf16 v[128:143], v[48:51], v[40:43], v[128:143]
    ds_read_b64_tr_b16 v[46:47], v6 offset:9984
    ds_read_b64_tr_b16 v[48:49], v6 offset:9248
    v_mfma_f32_32x32x16_bf16 v[144:159], v[52:55], v[40:43], v[144:159]
    ds_read_b64_tr_b16 v[50:51], v6 offset:10016
    v_add_u32 v4, s13, v4
    s_waitcnt lgkmcnt(10)
    v_mfma_f32_32x32x16_bf16 v[64:79], v[24:27], v[16:19], v[64:79]
    ds_read_b64_tr_b16 v[52:53], v6 offset:9280
    ds_read_b64_tr_b16 v[54:55], v6 offset:10048
    s_waitcnt lgkmcnt(10)
    v_mfma_f32_32x32x16_bf16 v[80:95], v[28:31], v[16:19], v[80:95]
    ds_read_b128 v[40:43], v5 offset:4096
    v_add_u32 v6, s13, v6
    s_waitcnt lgkmcnt(9)
    v_mfma_f32_32x32x16_bf16 v[96:111], v[32:35], v[16:19], v[96:111]
    s_waitcnt vmcnt(0)
    s_waitcnt lgkmcnt(8)
    v_mfma_f32_32x32x16_bf16 v[112:127], v[24:27], v[20:23], v[112:127]
    s_waitcnt lgkmcnt(0)
    s_barrier
    ds_read_b128 v[16:19], v2
    ds_read_b64_tr_b16 v[24:25], v6 offset:0
    v_mfma_f32_32x32x16_bf16 v[128:143], v[28:31], v[20:23], v[128:143]
    ds_read_b64_tr_b16 v[26:27], v6 offset:768
    ds_read_b64_tr_b16 v[28:29], v6 offset:32
    v_mfma_f32_32x32x16_bf16 v[144:159], v[32:35], v[20:23], v[144:159]
    ds_read_b64_tr_b16 v[30:31], v6 offset:800
    v_mfma_f32_32x32x16_bf16 v[64:79], v[44:47], v[36:39], v[64:79]
    ds_read_b64_tr_b16 v[32:33], v6 offset:64
    ds_read_b64_tr_b16 v[34:35], v6 offset:832
    v_mfma_f32_32x32x16_bf16 v[80:95], v[48:51], v[36:39], v[80:95]
    ds_read_b128 v[20:23], v2 offset:4096
    v_add_u32_e64 v5, s13, v5
    v_mfma_f32_32x32x16_bf16 v[96:111], v[52:55], v[36:39], v[96:111]
    ds_read_b128 v[36:39], v3
    s_cmp_lt_u32 s11, 7
    v_mfma_f32_32x32x16_bf16 v[112:127], v[44:47], v[40:43], v[112:127]
    ds_read_b64_tr_b16 v[44:45], v6 offset:3072
    v_mfma_f32_32x32x16_bf16 v[128:143], v[48:51], v[40:43], v[128:143]
    ds_read_b64_tr_b16 v[46:47], v6 offset:3840
    ds_read_b64_tr_b16 v[48:49], v6 offset:3104
    v_mfma_f32_32x32x16_bf16 v[144:159], v[52:55], v[40:43], v[144:159]
    ds_read_b64_tr_b16 v[50:51], v6 offset:3872
    s_cbranch_scc1 g1_68
    s_waitcnt lgkmcnt(10)
    v_mfma_f32_32x32x16_bf16 v[64:79], v[24:27], v[16:19], v[64:79]
    ds_read_b64_tr_b16 v[52:53], v6 offset:3136
    ds_read_b64_tr_b16 v[54:55], v6 offset:3904
    s_waitcnt lgkmcnt(10)
    v_mfma_f32_32x32x16_bf16 v[80:95], v[28:31], v[16:19], v[80:95]
    ds_read_b128 v[40:43], v3 offset:4096
    s_waitcnt lgkmcnt(9)
    v_mfma_f32_32x32x16_bf16 v[96:111], v[32:35], v[16:19], v[96:111]
    ds_read_b128 v[16:19], v4
    s_waitcnt lgkmcnt(9)
    v_mfma_f32_32x32x16_bf16 v[112:127], v[24:27], v[20:23], v[112:127]
    ds_read_b64_tr_b16 v[24:25], v6 offset:6144
    v_mfma_f32_32x32x16_bf16 v[128:143], v[28:31], v[20:23], v[128:143]
    ds_read_b64_tr_b16 v[26:27], v6 offset:6912
    ds_read_b64_tr_b16 v[28:29], v6 offset:6176
    v_mfma_f32_32x32x16_bf16 v[144:159], v[32:35], v[20:23], v[144:159]
    ds_read_b64_tr_b16 v[30:31], v6 offset:6944
    v_add_u32 v3, s17, v3
    v_subrev_u32 v7, 8, v7
    s_waitcnt lgkmcnt(10)
    v_mfma_f32_32x32x16_bf16 v[64:79], v[44:47], v[36:39], v[64:79]
    ds_read_b64_tr_b16 v[32:33], v6 offset:6208
    ds_read_b64_tr_b16 v[34:35], v6 offset:6976
    s_waitcnt lgkmcnt(10)
    v_mfma_f32_32x32x16_bf16 v[80:95], v[48:51], v[36:39], v[80:95]
    ds_read_b128 v[20:23], v4 offset:4096
    v_add_u32 v2, s17, v2
    s_waitcnt lgkmcnt(9)
    v_mfma_f32_32x32x16_bf16 v[96:111], v[52:55], v[36:39], v[96:111]
    ds_read_b128 v[36:39], v5
    s_nop 0
    s_waitcnt lgkmcnt(9)
    v_mfma_f32_32x32x16_bf16 v[112:127], v[44:47], v[40:43], v[112:127]
    ds_read_b64_tr_b16 v[44:45], v6 offset:9216
    ds_read_b32 v13, v7 offset:4
    v_mfma_f32_32x32x16_bf16 v[128:143], v[48:51], v[40:43], v[128:143]
    ds_read_b64_tr_b16 v[46:47], v6 offset:9984
    ds_read_b64_tr_b16 v[48:49], v6 offset:9248
    v_mfma_f32_32x32x16_bf16 v[144:159], v[52:55], v[40:43], v[144:159]
    ds_read_b64_tr_b16 v[50:51], v6 offset:10016
    v_add_u32 v4, s17, v4
    s_waitcnt lgkmcnt(11)
    v_mfma_f32_32x32x16_bf16 v[64:79], v[24:27], v[16:19], v[64:79]
    ds_read_b64_tr_b16 v[52:53], v6 offset:9280
    ds_read_b64_tr_b16 v[54:55], v6 offset:10048
    s_waitcnt lgkmcnt(11)
    v_mfma_f32_32x32x16_bf16 v[80:95], v[28:31], v[16:19], v[80:95]
    ds_read_b128 v[40:43], v5 offset:4096
    v_add_u32 v6, s17, v6
    s_waitcnt lgkmcnt(10)
    v_mfma_f32_32x32x16_bf16 v[96:111], v[32:35], v[16:19], v[96:111]
    s_waitcnt lgkmcnt(6)
    v_cmp_ne_u32 vcc, 0, v13
    s_cbranch_vccnz g1s_70
g1b_71:
    ds_read_b128 v[16:19], v2
    v_mfma_f32_32x32x16_bf16 v[112:127], v[24:27], v[20:23], v[112:127]
    ds_read_b64_tr_b16 v[24:25], v6 offset:0
    v_mfma_f32_32x32x16_bf16 v[128:143], v[28:31], v[20:23], v[128:143]
    ds_read_b64_tr_b16 v[26:27], v6 offset:768
    ds_read_b64_tr_b16 v[28:29], v6 offset:32
    v_mfma_f32_32x32x16_bf16 v[144:159], v[32:35], v[20:23], v[144:159]
    ds_read_b64_tr_b16 v[30:31], v6 offset:800
    s_waitcnt lgkmcnt(10)
    v_mfma_f32_32x32x16_bf16 v[64:79], v[44:47], v[36:39], v[64:79]
    ds_read_b64_tr_b16 v[32:33], v6 offset:64
    ds_read_b64_tr_b16 v[34:35], v6 offset:832
    s_waitcnt lgkmcnt(10)
    v_mfma_f32_32x32x16_bf16 v[80:95], v[48:51], v[36:39], v[80:95]
    ds_read_b128 v[20:23], v2 offset:4096
    v_add_u32 v5, s17, v5
    s_waitcnt lgkmcnt(9)
    v_mfma_f32_32x32x16_bf16 v[96:111], v[52:55], v[36:39], v[96:111]
    ds_read_b128 v[36:39], v3
    s_waitcnt lgkmcnt(9)
    v_mfma_f32_32x32x16_bf16 v[112:127], v[44:47], v[40:43], v[112:127]
    ds_read_b64_tr_b16 v[44:45], v6 offset:3072
    v_mfma_f32_32x32x16_bf16 v[128:143], v[48:51], v[40:43], v[128:143]
    ds_read_b64_tr_b16 v[46:47], v6 offset:3840
    ds_read_b64_tr_b16 v[48:49], v6 offset:3104
    v_mfma_f32_32x32x16_bf16 v[144:159], v[52:55], v[40:43], v[144:159]
    ds_read_b64_tr_b16 v[50:51], v6 offset:3872
    s_waitcnt lgkmcnt(10)
    v_mfma_f32_32x32x16_bf16 v[64:79], v[24:27], v[16:19], v[64:79]
    ds_read_b64_tr_b16 v[52:53], v6 offset:3136
    ds_read_b64_tr_b16 v[54:55], v6 offset:3904
    ds_read_b32 v12, v7
    s_waitcnt lgkmcnt(11)
    v_mfma_f32_32x32x16_bf16 v[80:95], v[28:31], v[16:19], v[80:95]
    ds_read_b128 v[40:43], v3 offset:4096
    s_waitcnt lgkmcnt(10)
    v_mfma_f32_32x32x16_bf16 v[96:111], v[32:35], v[16:19], v[96:111]
    ds_read_b128 v[16:19], v4
    s_waitcnt lgkmcnt(10)
    v_mfma_f32_32x32x16_bf16 v[112:127], v[24:27], v[20:23], v[112:127]
    s_waitcnt lgkmcnt(2)
    v_cmp_ne_u32 vcc, 0, v12
    s_cbranch_vccnz g1s_72
g1b_73:
    ds_read_b64_tr_b16 v[24:25], v6 offset:6144
    v_mfma_f32_32x32x16_bf16 v[128:143], v[28:31], v[20:23], v[128:143]
    ds_read_b64_tr_b16 v[26:27], v6 offset:6912
    ds_read_b64_tr_b16 v[28:29], v6 offset:6176
    v_mfma_f32_32x32x16_bf16 v[144:159], v[32:35], v[20:23], v[144:159]
    ds_read_b64_tr_b16 v[30:31], v6 offset:6944
    v_add_u32 v3, s16, v3
    v_subrev_u32 v7, 8, v7
    v_mfma_f32_32x32x16_bf16 v[64:79], v[44:47], v[36:39], v[64:79]
    ds_read_b64_tr_b16 v[32:33], v6 offset:6208
    ds_read_b64_tr_b16 v[34:35], v6 offset:6976
    v_mfma_f32_32x32x16_bf16 v[80:95], v[48:51], v[36:39], v[80:95]
    ds_read_b128 v[20:23], v4 offset:4096
    v_add_u32_e64 v2, s16, v2
    v_mfma_f32_32x32x16_bf16 v[96:111], v[52:55], v[36:39], v[96:111]
    ds_read_b128 v[36:39], v5
    s_nop 0
    s_waitcnt lgkmcnt(9)
    v_mfma_f32_32x32x16_bf16 v[112:127], v[44:47], v[40:43], v[112:127]
    ds_read_b64_tr_b16 v[44:45], v6 offset:9216
    ds_read_b32 v13, v7 offset:4
    v_mfma_f32_32x32x16_bf16 v[128:143], v[48:51], v[40:43], v[128:143]
    ds_read_b64_tr_b16 v[46:47], v6 offset:9984
    ds_read_b64_tr_b16 v[48:49], v6 offset:9248
    v_mfma_f32_32x32x16_bf16 v[144:159], v[52:55], v[40:43], v[144:159]
    ds_read_b64_tr_b16 v[50:51], v6 offset:10016
    v_add_u32 v4, s16, v4
    s_waitcnt lgkmcnt(11)
    v_mfma_f32_32x32x16_bf16 v[64:79], v[24:27], v[16:19], v[64:79]
    ds_read_b64_tr_b16 v[52:53], v6 offset:9280
    ds_read_b64_tr_b16 v[54:55], v6 offset:10048
    s_waitcnt lgkmcnt(11)
    v_mfma_f32_32x32x16_bf16 v[80:95], v[28:31], v[16:19], v[80:95]
    ds_read_b128 v[40:43], v5 offset:4096
    v_add_u32 v6, s16, v6
    buffer_load_dwordx4 v[160:163], v1, s[20:23], s14 offen offset:0 sc1
    s_waitcnt lgkmcnt(10)
    v_mfma_f32_32x32x16_bf16 v[96:111], v[32:35], v[16:19], v[96:111]
    s_waitcnt lgkmcnt(6)
    v_cmp_ne_u32 vcc, 0, v13
    s_cbranch_vccnz g1s_74
g1b_75:
    ds_read_b128 v[16:19], v2
    buffer_load_dwordx4 v[164:167], v1, s[20:23], s14 offen offset:1024 sc1
    v_mfma_f32_32x32x16_bf16 v[112:127], v[24:27], v[20:23], v[112:127]
    ds_read_b64_tr_b16 v[24:25], v6 offset:0
    buffer_load_dwordx4 v[168:171], v1, s[20:23], s14 offen offset:2048 sc1
    v_mfma_f32_32x32x16_bf16 v[128:143], v[28:31], v[20:23], v[128:143]
    ds_read_b64_tr_b16 v[26:27], v6 offset:768
    ds_read_b64_tr_b16 v[28:29], v6 offset:32
    v_mfma_f32_32x32x16_bf16 v[144:159], v[32:35], v[20:23], v[144:159]
    ds_read_b64_tr_b16 v[30:31], v6 offset:800
    buffer_load_dwordx4 v[172:175], v1, s[20:23], s14 offen offset:3072 sc1
    s_add_u32 s14, s14, 4096
    s_waitcnt lgkmcnt(10)
    v_mfma_f32_32x32x16_bf16 v[64:79], v[44:47], v[36:39], v[64:79]
    ds_read_b64_tr_b16 v[32:33], v6 offset:64
    ds_read_b64_tr_b16 v[34:35], v6 offset:832
    s_waitcnt lgkmcnt(10)
    v_mfma_f32_32x32x16_bf16 v[80:95], v[48:51], v[36:39], v[80:95]
    ds_read_b128 v[20:23], v2 offset:4096
    v_add_u32_e64 v5, s16, v5
    buffer_load_dwordx4 v[176:179], v1, s[20:23], s14 offen offset:0 sc1
    s_waitcnt lgkmcnt(9)
    v_mfma_f32_32x32x16_bf16 v[96:111], v[52:55], v[36:39], v[96:111]
    ds_read_b128 v[36:39], v3
    buffer_load_dwordx4 v[180:183], v1, s[20:23], s14 offen offset:1024 sc1
    s_waitcnt lgkmcnt(9)
    v_mfma_f32_32x32x16_bf16 v[112:127], v[44:47], v[40:43], v[112:127]
    ds_read_b64_tr_b16 v[44:45], v6 offset:3072
    buffer_load_dwordx4 v[184:187], v1, s[20:23], s14 offen offset:2048 sc1
    v_mfma_f32_32x32x16_bf16 v[128:143], v[48:51], v[40:43], v[128:143]
    ds_read_b64_tr_b16 v[46:47], v6 offset:3840
    ds_read_b64_tr_b16 v[48:49], v6 offset:3104
    v_mfma_f32_32x32x16_bf16 v[144:159], v[52:55], v[40:43], v[144:159]
    ds_read_b64_tr_b16 v[50:51], v6 offset:3872
    buffer_load_dwordx4 v[188:191], v1, s[20:23], s14 offen offset:3072 sc1
    s_add_u32 s14, s14, 4096
    s_waitcnt lgkmcnt(10)
    v_mfma_f32_32x32x16_bf16 v[64:79], v[24:27], v[16:19], v[64:79]
    ds_read_b64_tr_b16 v[52:53], v6 offset:3136
    ds_read_b64_tr_b16 v[54:55], v6 offset:3904
    ds_read_b32 v12, v7
    s_waitcnt lgkmcnt(11)
    v_mfma_f32_32x32x16_bf16 v[80:95], v[28:31], v[16:19], v[80:95]
    ds_read_b128 v[40:43], v3 offset:4096
    buffer_load_dwordx4 v[192:195], v1, s[20:23], s14 offen offset:0 sc1
    s_waitcnt lgkmcnt(10)
    v_mfma_f32_32x32x16_bf16 v[96:111], v[32:35], v[16:19], v[96:111]
    ds_read_b128 v[16:19], v4
    buffer_load_dwordx4 v[196:199], v1, s[20:23], s14 offen offset:1024 sc1
    s_waitcnt lgkmcnt(10)
    v_mfma_f32_32x32x16_bf16 v[112:127], v[24:27], v[20:23], v[112:127]
    s_waitcnt lgkmcnt(2)
    v_cmp_ne_u32 vcc, 0, v12
    s_nop 0
    s_cbranch_vccnz g1s_76
g1b_77:
    ds_read_b64_tr_b16 v[24:25], v6 offset:6144
    buffer_load_dwordx4 v[200:203], v1, s[20:23], s14 offen offset:2048 sc1
    v_mfma_f32_32x32x16_bf16 v[128:143], v[28:31], v[20:23], v[128:143]
    ds_read_b64_tr_b16 v[26:27], v6 offset:6912
    ds_read_b64_tr_b16 v[28:29], v6 offset:6176
    v_mfma_f32_32x32x16_bf16 v[144:159], v[32:35], v[20:23], v[144:159]
    ds_read_b64_tr_b16 v[30:31], v6 offset:6944
    buffer_load_dwordx4 v[204:207], v1, s[20:23], s14 offen offset:3072 sc1
    s_add_u32 s14, s14, 4096
    v_mfma_f32_32x32x16_bf16 v[64:79], v[44:47], v[36:39], v[64:79]
    ds_read_b64_tr_b16 v[32:33], v6 offset:6208
    ds_read_b64_tr_b16 v[34:35], v6 offset:6976
    v_mfma_f32_32x32x16_bf16 v[80:95], v[48:51], v[36:39], v[80:95]
    ds_read_b128 v[20:23], v4 offset:4096
    buffer_load_dwordx4 v[208:211], v1, s[20:23], s14 offen offset:0 sc1
    v_mfma_f32_32x32x16_bf16 v[96:111], v[52:55], v[36:39], v[96:111]
    ds_read_b128 v[36:39], v5
    buffer_load_dwordx4 v[212:215], v1, s[20:23], s14 offen offset:1024 sc1
    s_nop 0
    s_waitcnt lgkmcnt(9)
    v_mfma_f32_32x32x16_bf16 v[112:127], v[44:47], v[40:43], v[112:127]
    ds_read_b64_tr_b16 v[44:45], v6 offset:9216
    buffer_load_dwordx4 v[216:219], v1, s[20:23], s14 offen offset:2048 sc1
    v_mfma_f32_32x32x16_bf16 v[128:143], v[48:51], v[40:43], v[128:143]
    ds_read_b64_tr_b16 v[46:47], v6 offset:9984
    ds_read_b64_tr_b16 v[48:49], v6 offset:9248
    v_mfma_f32_32x32x16_bf16 v[144:159], v[52:55], v[40:43], v[144:159]
    ds_read_b64_tr_b16 v[50:51], v6 offset:10016
    buffer_load_dwordx4 v[220:223], v1, s[20:23], s14 offen offset:3072 sc1
    s_add_u32 s14, s14, 4096
    s_waitcnt lgkmcnt(10)
    v_mfma_f32_32x32x16_bf16 v[64:79], v[24:27], v[16:19], v[64:79]
    ds_read_b64_tr_b16 v[52:53], v6 offset:9280
    ds_read_b64_tr_b16 v[54:55], v6 offset:10048
    s_waitcnt lgkmcnt(10)
    v_mfma_f32_32x32x16_bf16 v[80:95], v[28:31], v[16:19], v[80:95]
    ds_read_b128 v[40:43], v5 offset:4096
    buffer_load_dwordx4 v[224:227], v1, s[20:23], s14 offen offset:0 sc1
    s_waitcnt lgkmcnt(9)
    v_mfma_f32_32x32x16_bf16 v[96:111], v[32:35], v[16:19], v[96:111]
    buffer_load_dwordx4 v[228:231], v1, s[20:23], s14 offen offset:1024 sc1
    s_waitcnt lgkmcnt(8)
    v_mfma_f32_32x32x16_bf16 v[112:127], v[24:27], v[20:23], v[112:127]
    buffer_load_dwordx4 v[232:235], v1, s[20:23], s14 offen offset:2048 sc1
    v_mfma_f32_32x32x16_bf16 v[128:143], v[28:31], v[20:23], v[128:143]
    v_mfma_f32_32x32x16_bf16 v[144:159], v[32:35], v[20:23], v[144:159]
    s_setprio 2
    buffer_load_dwordx4 v[236:239], v1, s[20:23], s14 offen offset:3072 sc1
    s_add_u32 s14, s14, 4096
    s_waitcnt lgkmcnt(5)
    v_mfma_f32_32x32x16_bf16 v[64:79], v[44:47], v[36:39], v[64:79]
    s_waitcnt lgkmcnt(3)
    v_mfma_f32_32x32x16_bf16 v[80:95], v[48:51], v[36:39], v[80:95]
    buffer_load_dwordx4 v[240:243], v1, s[20:23], s14 offen offset:0 sc1
    s_waitcnt lgkmcnt(1)
    v_mfma_f32_32x32x16_bf16 v[96:111], v[52:55], v[36:39], v[96:111]
    buffer_load_dwordx4 v[244:247], v1, s[20:23], s14 offen offset:1024 sc1
    s_waitcnt lgkmcnt(0)
    v_mfma_f32_32x32x16_bf16 v[112:127], v[44:47], v[40:43], v[112:127]
    v_mfma_f32_32x32x16_bf16 v[128:143], v[48:51], v[40:43], v[128:143]
    v_mfma_f32_32x32x16_bf16 v[144:159], v[52:55], v[40:43], v[144:159]
    s_branch k_mj
k_ls:
    v_add_u32_e64 v9, 0, v0
    v_mul_u32_u24 v22, 5462, v9
    v_lshrrev_b32_e64 v22, 16, v22
    v_mul_u32_u24 v22, 2880, v22
    v_lshl_add_u32 v10, v0, 4, v22
    v_add_u32_e64 v9, 64, v0
    v_mul_u32_u24 v22, 5462, v9
    v_lshrrev_b32_e64 v22, 16, v22
    v_mul_u32_u24 v22, 2880, v22
    v_lshl_add_u32 v11, v0, 4, v22
    v_add_u32 v9, 128, v0
    v_mul_u32_u24 v22, 5462, v9
    v_lshrrev_b32_e64 v22, 16, v22
    v_mul_u32_u24 v22, 2880, v22
    v_lshl_add_u32 v12, v0, 4, v22
    s_mul_i32 s26, s4, 163840
    s_mul_i32 s27, s5, 192
ld_78:
    s_add_u32 m0, s29, 16384
    s_add_u32 s28, s27, 0
    buffer_load_dwordx4 v10, s[12:15], s28 offen offset:0 lds
    s_add_u32 s33, s29, 41024
    buffer_load_dwordx4 v11, s[12:15], s28 offen offset:1024 lds
    s_cmp_eq_u32 s33, 123072
    s_cselect_b32 s33, 0, s33
    buffer_load_dwordx4 v12, s[12:15], s28 offen offset:2048 lds
    s_add_u32 m0, s29, 28704
    s_nop 0
    buffer_load_dwordx4 v10, s[16:19], s28 offen offset:0 lds
    buffer_load_dwordx4 v11, s[16:19], s28 offen offset:1024 lds
    s_add_u32 s30, s30, 1
    buffer_load_dwordx4 v12, s[16:19], s28 offen offset:2048 lds
    s_add_u32 m0, s29, 19456
    s_add_u32 s28, s27, 49152
    buffer_load_dwordx4 v10, s[12:15], s28 offen offset:0 lds
    buffer_load_dwordx4 v11, s[12:15], s28 offen offset:1024 lds
    buffer_load_dwordx4 v12, s[12:15], s28 offen offset:2048 lds
    s_add_u32 m0, s29, 31776
    s_nop 0
    buffer_load_dwordx4 v10, s[16:19], s28 offen offset:0 lds
    buffer_load_dwordx4 v11, s[16:19], s28 offen offset:1024 lds
    buffer_load_dwordx4 v12, s[16:19], s28 offen offset:2048 lds
    s_add_u32 m0, s29, 0
    s_add_u32 s28, s26, 0
    s_nop 0
    buffer_load_dwordx4 v2, s[8:11], s28 offen offset:0 lds
    buffer_load_dwordx4 v3, s[8:11], s28 offen offset:1024 lds
    buffer_load_dwordx4 v4, s[8:11], s28 offen offset:2048 lds
    buffer_load_dwordx4 v5, s[8:11], s28 offen offset:3072 lds
    s_add_u32 m0, s29, 4096
    s_add_u32 s28, s26, 40960
    buffer_load_dwordx4 v2, s[8:11], s28 offen offset:0 lds
    buffer_load_dwordx4 v3, s[8:11], s28 offen offset:1024 lds
    buffer_load_dwordx4 v4, s[8:11], s28 offen offset:2048 lds
    buffer_load_dwordx4 v5, s[8:11], s28 offen offset:3072 lds
    s_add_u32 m0, s29, 8192
    s_add_u32 s28, s26, 81920
    buffer_load_dwordx4 v2, s[8:11], s28 offen offset:0 lds
    buffer_load_dwordx4 v3, s[8:11], s28 offen offset:1024 lds
    buffer_load_dwordx4 v4, s[8:11], s28 offen offset:2048 lds
    buffer_load_dwordx4 v5, s[8:11], s28 offen offset:3072 lds
    s_add_u32 m0, s29, 12288
    s_add_u32 s28, s26, 122880
    buffer_load_dwordx4 v2, s[8:11], s28 offen offset:0 lds
    buffer_load_dwordx4 v3, s[8:11], s28 offen offset:1024 lds
    s_add_u32 s26, s26, 128
    buffer_load_dwordx4 v4, s[8:11], s28 offen offset:2048 lds
    buffer_load_dwordx4 v5, s[8:11], s28 offen offset:3072 lds
    s_mov_b32 m0, s31
    s_sub_u32 s31, s31, 4
    buffer_load_dword v14, s[8:11], 0 offen lds
    s_add_u32 m0, s29, 22528
    s_add_u32 s28, s27, 98304
    buffer_load_dwordx4 v10, s[12:15], s28 offen offset:0 lds
    buffer_load_dwordx4 v11, s[12:15], s28 offen offset:1024 lds
    buffer_load_dwordx4 v12, s[12:15], s28 offen offset:2048 lds
    s_add_u32 m0, s29, 34848
    s_nop 0
    s_nop 0
    buffer_load_dwordx4 v10, s[16:19], s28 offen offset:0 lds
    buffer_load_dwordx4 v11, s[16:19], s28 offen offset:1024 lds
    buffer_load_dwordx4 v12, s[16:19], s28 offen offset:2048 lds
    s_add_u32 m0, s29, 25600
    s_add_u32 s28, s27, 147456
    buffer_load_dwordx4 v10, s[12:15], s28 offen offset:0 lds
    buffer_load_dwordx4 v11, s[12:15], s28 offen offset:1024 lds
    s_add_u32 s27, s27, 196608
    buffer_load_dwordx4 v12, s[12:15], s28 offen offset:2048 lds
    s_add_u32 m0, s29, 37920
    s_nop 0
    buffer_load_dwordx4 v10, s[16:19], s28 offen offset:0 lds
    buffer_load_dwordx4 v11, s[16:19], s28 offen offset:1024 lds
    s_mov_b32 s29, s33
    buffer_load_dwordx4 v12, s[16:19], s28 offen offset:2048 lds
    s_mov_b32 m0, s31
    s_sub_u32 s31, s31, 4
    buffer_load_dword v14, s[8:11], 0 offen lds
    s_bitcmp0_b32 s36, s30
    s_cbranch_scc1 sk_79
    s_waitcnt vmcnt(42)
    s_barrier
sk_79:
    s_cmp_lt_u32 s30, 10
    s_cbranch_scc1 ld_78
    s_branch k_lj
g1s_9:
    s_mov_b32 s62, 0
lw_80:
    ds_read_b32 v13, v7 offset:4
    s_addk_i32 s62, 1
    s_waitcnt lgkmcnt(0)
    v_cmp_ne_u32 vcc, 0, v13
    s_cbranch_vccz lw_81
    s_cmpk_lt_u32 s62, 0x7000
    s_cbranch_scc1 lw_80
lw_81:
    s_branch g1b_10
g1s_11:
    s_mov_b32 s62, 0
lw_82:
    ds_read_b32 v12, v7 offset:0
    s_addk_i32 s62, 1
    s_waitcnt lgkmcnt(0)
    v_cmp_ne_u32 vcc, 0, v12
    s_cbranch_vccz lw_83
    s_cmpk_lt_u32 s62, 0x7000
    s_cbranch_scc1 lw_82
lw_83:
    s_branch g1b_12
g1s_13:
    s_mov_b32 s62, 0
lw_84:
    ds_read_b32 v13, v7 offset:4
    s_addk_i32 s62, 1
    s_waitcnt lgkmcnt(0)
    v_cmp_ne_u32 vcc, 0, v13
    s_cbranch_vccz lw_85
    s_cmpk_lt_u32 s62, 0x7000
    s_cbranch_scc1 lw_84
lw_85:
    s_branch g1b_14
g1s_15:
    s_mov_b32 s62, 0
lw_86:
    ds_read_b32 v12, v7 offset:0
    s_addk_i32 s62, 1
    s_waitcnt lgkmcnt(0)
    v_cmp_ne_u32 vcc, 0, v12
    s_cbranch_vccz lw_87
    s_cmpk_lt_u32 s62, 0x7000
    s_cbranch_scc1 lw_86
lw_87:
    s_branch g1b_16
g1s_70:
    s_mov_b32 s62, 0
lw_88:
    ds_read_b32 v13, v7 offset:4
    s_addk_i32 s62, 1
    s_waitcnt lgkmcnt(0)
    v_cmp_ne_u32 vcc, 0, v13
    s_cbranch_vccz lw_89
    s_cmpk_lt_u32 s62, 0x7000
    s_cbranch_scc1 lw_88
lw_89:
    s_branch g1b_71
g1s_72:
    s_mov_b32 s62, 0
lw_90:
    ds_read_b32 v12, v7 offset:0
    s_addk_i32 s62, 1
    s_waitcnt lgkmcnt(0)
    v_cmp_ne_u32 vcc, 0, v12
    s_cbranch_vccz lw_91
    s_cmpk_lt_u32 s62, 0x7000
    s_cbranch_scc1 lw_90
lw_91:
    s_branch g1b_73
g1s_74:
    s_mov_b32 s62, 0
lw_92:
    ds_read_b32 v13, v7 offset:4
    s_addk_i32 s62, 1
    s_waitcnt lgkmcnt(0)
    v_cmp_ne_u32 vcc, 0, v13
    s_cbranch_vccz lw_93
    s_cmpk_lt_u32 s62, 0x7000
    s_cbranch_scc1 lw_92
lw_93:
    s_branch g1b_75
g1s_76:
    s_mov_b32 s62, 0
lw_94:
    ds_read_b32 v12, v7 offset:0
    s_addk_i32 s62, 1
    s_waitcnt lgkmcnt(0)
    v_cmp_ne_u32 vcc, 0, v12
    s_cbranch_vccz lw_95
    s_cmpk_lt_u32 s62, 0x7000
    s_cbranch_scc1 lw_94
lw_95:
    s_branch g1b_77
k_last:
    s_endpgm
.section .rodata,"a"
.p2align 6
.amdhsa_kernel gated_mix__ssm_conv_s4d__swiglu_ffn__prompt_kernel
  .amdhsa_next_free_vgpr 256
  .amdhsa_next_free_sgpr 102
  .amdhsa_accum_offset 256
  .amdhsa_group_segment_fixed_size 0
  .amdhsa_kernarg_size 120
  .amdhsa_user_sgpr_count 2
  .amdhsa_user_sgpr_kernarg_segment_ptr 1
  .amdhsa_system_sgpr_workgroup_id_x 1
.end_amdhsa_kernel
```
